```python
import torch

def _softmax(x, axis=-1):
    return torch.softmax(x, dim=axis)
def _gelu(x):
    return torch.nn.functional.gelu(x, approximate="tanh")
def _silu(x):
    return torch.nn.functional.silu(x)
def _sigmoid(x):
    return torch.sigmoid(x)
def _layernorm(x, axis=-1, eps=1e-5):
    m = x.mean(dim=axis, keepdim=True)
    v = x.var(dim=axis, keepdim=True, unbiased=False)
    return (x - m) / torch.sqrt(v + eps)
def _scatter_add(tgt, idx, src, axis=0):
    return tgt.clone().index_add_(axis, idx, src)
def _segment_sum(src, seg, n):
    out = torch.zeros((n,) + src.shape[1:], dtype=src.dtype)
    return out.index_add_(0, seg, src)
def _pad(x, pw):
    flat = tuple(v for pair in reversed(pw) for v in pair)
    return torch.nn.functional.pad(x, flat)

kernel_name = 'standalone__global_local_windowed_global_tokens__prompt'

def setup_inputs():

    _w = (lambda a: (lambda t: t.to(torch.bfloat16) if t.is_floating_point() else t)(torch.as_tensor(a)))
    B, H, S, D = 1, 32, 2048, 128
    return {
        "q": _w((lambda *s: torch.randn(*s, dtype=torch.bfloat16) * 0.8)(B, H, S, D)),
        "k": _w((lambda *s: torch.randn(*s, dtype=torch.bfloat16) * 0.8)(B, H, S, D)),
        "v": _w((lambda *s: torch.randn(*s, dtype=torch.bfloat16) * 0.05)(B, H, S, D)),
        "window": 32,
        "n_global": 2,
    }

def reference(q, k, v, window, n_global):
    B, H, S, D = q.shape
    scale = D ** -0.5
    scores = torch.einsum("bhqd,bhkd->bhqk", q, k) * scale
    idx = torch.arange(S)
    dist = idx[:, None] - idx[None, :]
    local = (dist <= window) & (dist >= -window)
    is_global_q = (idx < n_global)[:, None]
    is_global_k = (idx < n_global)[None, :]
    mask = local | is_global_q | is_global_k
    scores = torch.where(mask[None, None], scores, -1e9)
    p = _softmax(scores, axis=-1)
    return torch.einsum("bhqk,bhkd->bhqd", p, v)
```

```asm
; @launch grid=(256,1,1) block=(512,1,1) lds=163840
.amdgcn_target "amdgcn-amd-amdhsa--gfx950"
.text
.globl standalone__global_local_windowed_global_tokens__prompt_kernel
.p2align 8
.type standalone__global_local_windowed_global_tokens__prompt_kernel,@function
standalone__global_local_windowed_global_tokens__prompt_kernel:
    s_load_dwordx16 s[4:19], s[0:1], 0
    v_readfirstlane_b32 s40, v0
    s_cmp_ge_u32 s2, 256
    s_cbranch_scc1 L_end
    v_lshrrev_b32 v221, 4, v0
    v_xor_b32 v211, v221, v0
    v_and_b32 v211, 15, v211
    v_lshl_add_u32 v211, v221, 4, v211
    s_bfe_u32 s44, s2, 0x30003
    s_lshl_b32 s46, s44, 16
    v_lshl_add_u32 v211, v211, 4, s46
    s_and_b32 s41, s2, 7
    s_lshr_b32 s43, s2, 6
    s_lshl2_add_u32 s43, s41, s43
    s_lshl_b32 s45, s43, 19
    s_lshl_b32 m0, s40, 4
    s_mov_b32 s26, 0x80000
    s_mov_b32 s27, 0x20000
    s_movk_i32 s59, 11
L_base:
    s_getpc_b64 s[56:57]
    v_mul_u32_u24 v1, 24, v0
    global_load_dword v12, v1, s[56:57]
    s_cmp_ge_u32 s40, 256
    s_cbranch_scc1 L_helper
    s_waitcnt lgkmcnt(0)
    s_add_u32 s24, s6, s45
    s_addc_u32 s25, s7, 0
    buffer_load_dwordx4 v211, s[24:27], 0 offen  lds
    s_add_u32 m0, m0, 0x1000
    v_add_u32 v211, 0x1000, v211
    buffer_load_dwordx4 v211, s[24:27], 0 offen  lds
    s_add_u32 m0, m0, 0x1000
    v_add_u32 v211, 0x1000, v211
L_kloop:
    buffer_load_dwordx4 v211, s[24:27], 0 offen nt lds
    s_add_u32 m0, m0, 0x1000
    v_add_u32 v211, 0x1000, v211
    s_sub_u32 s59, s59, 1
    s_cbranch_scc0 L_kloop
    buffer_load_dwordx4 v211, s[24:27], 0 offen  lds
    s_add_u32 m0, m0, 0x1000
    v_add_u32 v211, 0x1000, v211
    buffer_load_dwordx4 v211, s[24:27], 0 offen  lds
    s_add_u32 m0, m0, 0x1000
    v_add_u32 v211, 0x1000, v211
    buffer_load_dwordx4 v211, s[24:27], 0 offen  lds
    s_add_u32 m0, m0, 0x1000
    v_add_u32 v211, 0x1000, v211
    buffer_load_dwordx4 v211, s[24:27], 0 offen  lds
    s_add_u32 m0, m0, 0x1000
    v_add_u32 v211, 0x1000, v211
    s_lshr_b32 s40, s40, 6
    v_and_b32 v208, 63, v0
    v_and_b32 v209, 15, v0
    v_bfe_u32 v210, v0, 4, 2
    s_lshl_b32 s48, s40, 10
    s_add_u32 s49, s48, s46
    s_mov_b32 s30, 0x80000
    s_mov_b32 s31, 0x20000
    s_mov_b32 s22, 0x80000
    s_mov_b32 s23, 0x20000
    s_mov_b32 s38, 0x4000
    s_mov_b32 s39, 0x20000
    s_and_b32 s62, s40, 3
    s_lshl_b32 s62, s62, 1
    s_cmp_lt_u32 s40, 4
    s_addc_u32 s62, s62, 0
    s_cmp_eq_u32 s44, 0
    s_cselect_b32 s50, 0x40000000, 0
    s_lshl_b32 s47, s62, 13
    s_add_u32 s47, s47, s46
    v_xor_b32 v213, v210, v209
    v_lshlrev_b32 v213, 4, v213
    v_lshl_add_u32 v213, v210, 8, v213
    v_add_u32 v213, s47, v213
    v_lshlrev_b32 v223, 4, v208
    s_lshl_b32 s41, s43, 14
    s_lshl_b32 s42, s44, 11
    s_mov_b32 s63, 0
    s_add_u32 s28, s8, s45
    s_addc_u32 s29, s9, 0
    s_add_u32 s20, s4, s45
    s_addc_u32 s21, s5, 0
    s_add_u32 s36, s18, s41
    s_addc_u32 s37, s19, 0
    s_branch L_v1
L_helper:
    s_setprio 3
    s_memrealtime s[60:61]
    s_lshr_b32 s40, s40, 6
    v_and_b32 v208, 63, v0
    v_and_b32 v209, 15, v0
    v_bfe_u32 v210, v0, 4, 2
    s_lshl_b32 s48, s40, 10
    s_add_u32 s49, s48, s46
    s_mov_b32 s30, 0x80000
    s_mov_b32 s31, 0x20000
    s_mov_b32 s22, 0x80000
    s_mov_b32 s23, 0x20000
    s_mov_b32 s38, 0x4000
    s_mov_b32 s39, 0x20000
    s_and_b32 s62, s40, 3
    s_lshl_b32 s62, s62, 1
    s_cmp_lt_u32 s40, 4
    s_addc_u32 s62, s62, 0
    s_cmp_eq_u32 s44, 0
    s_cselect_b32 s50, 0x40000000, 0
    s_lshl_b32 s47, s62, 13
    s_add_u32 s47, s47, s46
    v_xor_b32 v213, v210, v209
    v_lshlrev_b32 v213, 4, v213
    v_lshl_add_u32 v213, v210, 8, v213
    v_add_u32 v213, s47, v213
    v_lshlrev_b32 v223, 4, v208
    s_lshl_b32 s41, s43, 14
    s_lshl_b32 s42, s44, 11
    s_mov_b32 m0, 155648
    s_waitcnt lgkmcnt(0)
    s_add_u32 s24, s6, s45
    s_addc_u32 s25, s7, 0
    s_add_u32 s28, s8, s45
    s_addc_u32 s29, s9, 0
    s_add_u32 s20, s4, s45
    s_addc_u32 s21, s5, 0
    s_add_u32 s36, s18, s41
    s_addc_u32 s37, s19, 0
    s_or_b32 s63, s60, 1
    s_cmp_lg_u32 s40, 7
    s_cbranch_scc1 L_noclear
    s_lshl_b32 s47, s43, 3
    v_mov_b32 v228, s47
    v_mov_b32 v229, s63
    v_mov_b32 v230, 158848
    v_mov_b32 v231, 0
    s_mov_b64 exec, 1
    s_cmp_lg_u32 s44, 3
    s_cbranch_scc1 L_nopub
    global_store_dword v228, v229, s[16:17] sc0 sc1
L_nopub:
    ds_write_b32 v230, v231
    s_mov_b64 exec, -1
L_noclear:
    s_cmp_lg_u32 s40, 5
    s_cbranch_scc1 L_nosmall
    buffer_load_dwordx4 v223, s[24:27], 0 offen lds
    s_mov_b32 m0, 156672
    s_nop 0
    buffer_load_dwordx4 v223, s[20:23], 0 offen lds
    s_mov_b32 m0, 157696
    s_nop 0
    buffer_load_dwordx4 v223, s[28:31], 0 offen lds
L_nosmall:
    s_setprio 0
    s_branch L_nov1
L_v1:
    s_and_b32 s47, s40, 1
    s_lshl_b32 s47, s47, 2
    v_add_lshl_u32 v212, s47, v210, 1
    v_xor_b32 v212, v212, v209
    v_lshlrev_b32 v212, 4, v212
    v_lshl_add_u32 v212, v210, 8, v212
    s_add_u32 s49, s49, 4294959104
    v_add_u32 v212, s49, v212
    s_add_u32 m0, s48, 73728
    s_nop 0
    v_add_u32 v221, s50, v212
    buffer_load_dwordx4 v221, s[28:31], 0 offen lds
    s_add_u32 m0, m0, 0x1000
    v_add_u32 v212, 0x1000, v212
    v_add_u32 v221, s50, v212
    buffer_load_dwordx4 v221, s[28:31], 0 offen lds
    s_add_u32 m0, m0, 0x1000
    v_add_u32 v212, 0x1000, v212
    buffer_load_dwordx4 v212, s[28:31], 0 offen  lds
    s_add_u32 m0, m0, 0x1000
    v_add_u32 v212, 0x1000, v212
    buffer_load_dwordx4 v212, s[28:31], 0 offen  lds
    s_add_u32 m0, m0, 0x1000
    v_add_u32 v212, 0x1000, v212
    buffer_load_dwordx4 v212, s[28:31], 0 offen nt lds
    s_add_u32 m0, m0, 0x1000
    v_add_u32 v212, 0x1000, v212
    buffer_load_dwordx4 v212, s[28:31], 0 offen nt lds
    s_add_u32 m0, m0, 0x1000
    v_add_u32 v212, 0x1000, v212
    buffer_load_dwordx4 v212, s[28:31], 0 offen nt lds
    s_add_u32 m0, m0, 0x1000
    v_add_u32 v212, 0x1000, v212
    buffer_load_dwordx4 v212, s[28:31], 0 offen nt lds
    s_add_u32 m0, m0, 0x1000
    v_add_u32 v212, 0x1000, v212
    buffer_load_dwordx4 v212, s[28:31], 0 offen nt lds
    s_add_u32 m0, m0, 0x1000
    v_add_u32 v212, 0x1000, v212
    buffer_load_dwordx4 v212, s[28:31], 0 offen nt lds
    s_add_u32 m0, m0, 0x1000
    v_add_u32 v212, 0x1000, v212
    buffer_load_dwordx4 v212, s[28:31], 0 offen nt lds
    s_add_u32 m0, m0, 0x1000
    v_add_u32 v212, 0x1000, v212
    buffer_load_dwordx4 v212, s[28:31], 0 offen nt lds
L_nov1:
    s_add_u32 s32, s14, s45
    s_addc_u32 s33, s15, 0
    s_mov_b32 s34, 0x80000
    s_mov_b32 s35, 0x20000
    s_movk_i32 s41, 0x1000
    s_mov_b32 s3, 0
    s_mov_b32 s52, 0x3e0293ee
    s_mov_b32 s53, 0x3e0293ee
    v_mov_b32 v215, 0xff000000
    v_lshlrev_b32 v222, 2, v210
    v_cmp_eq_u32 s[54:55], 0, v210
    v_add_u32 v221, 0, v222
    v_cmp_ge_u32 vcc, v221, v209
    v_cmp_le_u32 s[60:61], v221, v209
    s_nop 0
    v_cndmask_b32 v248, v215, 0, vcc
    v_cndmask_b32 v252, v215, 0, s[60:61]
    v_add_u32 v221, 1, v222
    v_cmp_ge_u32 vcc, v221, v209
    v_cmp_le_u32 s[60:61], v221, v209
    s_nop 0
    v_cndmask_b32 v249, v215, 0, vcc
    v_cndmask_b32 v253, v215, 0, s[60:61]
    v_add_u32 v221, 2, v222
    v_cmp_ge_u32 vcc, v221, v209
    v_cmp_le_u32 s[60:61], v221, v209
    s_nop 0
    v_cndmask_b32 v250, v215, 0, vcc
    v_cndmask_b32 v254, v215, 0, s[60:61]
    v_add_u32 v221, 3, v222
    v_cmp_ge_u32 vcc, v221, v209
    v_cmp_le_u32 s[60:61], v221, v209
    s_nop 0
    v_cndmask_b32 v251, v215, 0, vcc
    v_cndmask_b32 v255, v215, 0, s[60:61]
    s_lshl_b32 s47, s62, 13
    v_xor_b32 v221, v210, v209
    v_lshlrev_b32 v221, 4, v221
    v_lshl_add_u32 v221, v209, 8, v221
    v_add_u32 v216, s47, v221
    v_xor_b32 v217, 64, v216
    v_xor_b32 v218, 128, v216
    v_xor_b32 v219, 192, v216
    v_mov_b32 v211, v216
    v_and_b32 v221, 1, v209
    v_lshlrev_b32 v215, 3, v221
    v_lshlrev_b32 v221, 8, v221
    v_lshl_add_u32 v221, v210, 4, v221
    v_add_u32 v214, 155648, v221
    v_bfe_u32 v221, v208, 2, 2
    v_and_b32 v222, 3, v208
    v_lshlrev_b32 v222, 3, v222
    v_lshl_add_u32 v221, v221, 8, v222
    v_add_u32 v220, 157696, v221
    v_lshrrev_b32 v221, 2, v208
    v_and_b32 v11, 7, v221
    v_lshl_add_u32 v222, v11, 5, v222
    v_lshl_add_u32 v222, v221, 8, v222
    s_add_u32 s48, s47, 73728
    v_add_u32 v0, s48, v222
    v_xor_b32 v1, 32, v0
    v_xor_b32 v2, 64, v0
    v_xor_b32 v3, 96, v0
    v_xor_b32 v4, 128, v0
    v_xor_b32 v5, 160, v0
    v_xor_b32 v6, 192, v0
    v_xor_b32 v7, 224, v0
    s_mov_b32 s48, s47
    v_mul_u32_u24 v221, 272, v209
    v_lshl_add_u32 v221, v210, 3, v221
    v_add_u32 v8, s48, v221
    v_mul_u32_u24 v221, 272, v210
    v_lshl_add_u32 v221, v209, 4, v221
    v_add_u32 v9, s48, v221
    s_add_u32 s47, s47, s46
    v_add_u32 v10, s47, v223
    s_lshr_b32 s51, s47, 8
    s_cmp_eq_u32 s51, 0
    s_cselect_b32 s56, 0, -1
    s_mov_b32 s57, -1
    s_cmp_eq_u32 s51, 864
    s_cselect_b32 s58, 1, 0
    s_lshl_b32 s47, s40, 4
    s_add_u32 s47, s47, 158720
    v_add_u32 v215, s47, v215
    s_waitcnt vmcnt(12) lgkmcnt(0)
    s_cmp_lt_u32 s40, 4
    s_cbranch_scc1 L_kw
    s_cmp_eq_u32 s40, 7
    s_cbranch_scc1 L_kw
    s_waitcnt vmcnt(0)
L_kw:
    s_barrier
    s_cmp_ge_u32 s40, 4
    s_cbranch_scc1 L_nov2
    s_add_u32 m0, m0, 0x1000
    v_add_u32 v212, 0x1000, v212
    buffer_load_dwordx4 v212, s[28:31], 0 offen nt lds
    s_add_u32 m0, m0, 0x1000
    v_add_u32 v212, 0x1000, v212
    buffer_load_dwordx4 v212, s[28:31], 0 offen nt lds
    s_add_u32 m0, m0, 0x1000
    v_add_u32 v212, 0x1000, v212
    buffer_load_dwordx4 v212, s[28:31], 0 offen nt lds
    s_add_u32 m0, m0, 0x1000
    v_add_u32 v212, 0x1000, v212
    buffer_load_dwordx4 v212, s[28:31], 0 offen nt lds
    s_add_u32 m0, m0, 0x1000
    v_add_u32 v212, 0x1000, v212
    buffer_load_dwordx4 v212, s[28:31], 0 offen  lds
    s_add_u32 m0, m0, 0x1000
    v_add_u32 v212, 0x1000, v212
    buffer_load_dwordx4 v212, s[28:31], 0 offen  lds
    s_add_u32 m0, m0, 0x1000
    v_add_u32 v212, 0x1000, v212
    buffer_load_dwordx4 v212, s[28:31], 0 offen  lds
    s_add_u32 m0, m0, 0x1000
    v_add_u32 v212, 0x1000, v212
    buffer_load_dwordx4 v212, s[28:31], 0 offen  lds
L_nov2:
    ds_read_b128 v[48:51], v216 offset:0
    ds_read_b128 v[52:55], v217 offset:0
    ds_read_b128 v[56:59], v218 offset:0
    ds_read_b128 v[60:63], v219 offset:0
    ds_read_b128 v[64:67], v216 offset:4096
    ds_read_b128 v[68:71], v217 offset:4096
    ds_read_b128 v[72:75], v218 offset:4096
    ds_read_b128 v[76:79], v219 offset:4096
    ds_read_b128 v[80:83], v216 offset:8192
    ds_read_b128 v[84:87], v217 offset:8192
    ds_read_b128 v[88:91], v218 offset:8192
    ds_read_b128 v[92:95], v219 offset:8192
    ds_read_b128 v[96:99], v216 offset:12288
    ds_read_b128 v[100:103], v217 offset:12288
    ds_read_b128 v[104:107], v218 offset:12288
    ds_read_b128 v[108:111], v219 offset:12288
    ds_read_b128 v[112:115], v214 offset:0
    ds_read_b128 v[116:119], v214 offset:64
    ds_read_b128 v[120:123], v214 offset:128
    ds_read_b128 v[124:127], v214 offset:192
    ds_read_b64_tr_b16 v[162:163], v220 offset:0
    ds_read_b64_tr_b16 v[166:167], v220 offset:32
    ds_read_b64_tr_b16 v[170:171], v220 offset:64
    ds_read_b64_tr_b16 v[174:175], v220 offset:96
    ds_read_b64_tr_b16 v[178:179], v220 offset:128
    ds_read_b64_tr_b16 v[182:183], v220 offset:160
    ds_read_b64_tr_b16 v[186:187], v220 offset:192
    ds_read_b64_tr_b16 v[190:191], v220 offset:224
    s_cmp_eq_u32 s40, 4
    s_cbranch_scc1 L_k01done
    v_subrev_u32 v216, 0x2000, v216
    v_subrev_u32 v217, 0x2000, v217
    v_subrev_u32 v218, 0x2000, v218
    v_subrev_u32 v219, 0x2000, v219
    ds_read_b128 v[16:19], v216 offset:0
    ds_read_b128 v[20:23], v217 offset:0
    ds_read_b128 v[24:27], v218 offset:0
    ds_read_b128 v[28:31], v219 offset:0
    ds_read_b128 v[32:35], v216 offset:4096
    ds_read_b128 v[36:39], v217 offset:4096
    ds_read_b128 v[40:43], v218 offset:4096
    ds_read_b128 v[44:47], v219 offset:4096
L_k01done:
    s_cmp_lt_u32 s40, 4
    s_cbranch_scc1 L_gk
    s_cmp_lg_u32 s40, 7
    s_cbranch_scc1 L_notag
    s_setprio 3
    s_lshl_b32 s47, s43, 3
    v_mov_b32 v228, s47
    v_mov_b32 v229, s63
    v_mov_b32 v230, 158848
    global_load_dword v231, v228, s[16:17]
    s_setprio 0
    s_waitcnt lgkmcnt(0)
    s_barrier
    v_mov_b32 v171, v211
    s_lshl_b32 m0, s62, 13
    v_xor_b32 v221, 64, v213
    v_xor_b32 v222, 128, v213
    v_xor_b32 v223, 192, v213
    buffer_load_dwordx4 v213, s[20:23], s3 offen offset:0 nt lds
    buffer_load_dwordx4 v221, s[20:23], s3 offen offset:1024 nt lds
    buffer_load_dwordx4 v222, s[20:23], s3 offen offset:2048 nt lds
    buffer_load_dwordx4 v223, s[20:23], s3 offen offset:3072 nt lds
    s_waitcnt vmcnt(4)
    s_cmp_eq_u32 s44, 3
    s_cselect_b64 vcc, -1, 0
    v_cndmask_b32 v231, v231, v229, vcc
    s_mov_b64 exec, 1
    ds_write_b32 v230, v231 offset:4
    s_mov_b64 exec, -1
    s_branch L_tagdone
L_notag:
    s_waitcnt lgkmcnt(0)
    s_barrier
    v_mov_b32 v171, v211
    s_lshl_b32 m0, s62, 13
    v_xor_b32 v221, 64, v213
    v_xor_b32 v222, 128, v213
    v_xor_b32 v223, 192, v213
    buffer_load_dwordx4 v213, s[20:23], s3 offen offset:0 nt lds
    buffer_load_dwordx4 v221, s[20:23], s3 offen offset:1024 nt lds
    buffer_load_dwordx4 v222, s[20:23], s3 offen offset:2048 nt lds
    buffer_load_dwordx4 v223, s[20:23], s3 offen offset:3072 nt lds
    s_cmp_lg_u32 s40, 4
    s_cbranch_scc1 L_nohalo
    s_sub_u32 s47, s50, 0x2000
    v_add_u32 v224, s47, v213
    s_mov_b32 m0, 65536
    v_xor_b32 v221, 64, v224
    v_xor_b32 v222, 128, v224
    v_xor_b32 v223, 192, v224
    buffer_load_dwordx4 v224, s[24:27], s3 offen offset:0  lds
    buffer_load_dwordx4 v221, s[24:27], s3 offen offset:1024  lds
    buffer_load_dwordx4 v222, s[24:27], s3 offen offset:2048  lds
    buffer_load_dwordx4 v223, s[24:27], s3 offen offset:3072  lds
    s_mov_b32 m0, 69632
    v_xor_b32 v221, 64, v224
    v_xor_b32 v222, 128, v224
    v_xor_b32 v223, 192, v224
    buffer_load_dwordx4 v224, s[24:27], s41 offen offset:0  lds
    buffer_load_dwordx4 v221, s[24:27], s41 offen offset:1024  lds
    buffer_load_dwordx4 v222, s[24:27], s41 offen offset:2048  lds
    buffer_load_dwordx4 v223, s[24:27], s41 offen offset:3072  lds
L_nohalo:
L_tagdone:
    s_waitcnt lgkmcnt(0)
    s_barrier
    s_lshl_b32 s47, s62, 13
    s_add_u32 m0, s47, 0x1000
    v_xor_b32 v221, 64, v213
    v_xor_b32 v222, 128, v213
    v_xor_b32 v223, 192, v213
    buffer_load_dwordx4 v213, s[20:23], s41 offen offset:0 nt lds
    buffer_load_dwordx4 v221, s[20:23], s41 offen offset:1024 nt lds
    buffer_load_dwordx4 v222, s[20:23], s41 offen offset:2048 nt lds
    buffer_load_dwordx4 v223, s[20:23], s41 offen offset:3072 nt lds
    ds_read_b64_tr_b16 v[196:197], v0 offset:0
    ds_read_b64_tr_b16 v[198:199], v0 offset:4096
    ds_read_b64_tr_b16 v[200:201], v1 offset:0
    ds_read_b64_tr_b16 v[202:203], v1 offset:4096
    ds_read_b64_tr_b16 v[204:205], v2 offset:0
    ds_read_b64_tr_b16 v[206:207], v2 offset:4096
    ds_read_b64_tr_b16 v[208:209], v3 offset:0
    ds_read_b64_tr_b16 v[210:211], v3 offset:4096
    ds_read_b64_tr_b16 v[212:213], v4 offset:0
    ds_read_b64_tr_b16 v[214:215], v4 offset:4096
    ds_read_b64_tr_b16 v[216:217], v5 offset:0
    ds_read_b64_tr_b16 v[218:219], v5 offset:4096
    ds_read_b64_tr_b16 v[220:221], v6 offset:0
    ds_read_b64_tr_b16 v[222:223], v6 offset:4096
    ds_read_b64_tr_b16 v[12:13], v7 offset:0
    ds_read_b64_tr_b16 v[14:15], v7 offset:4096
    s_branch L_gdone
L_gk:
    ds_read_b128 v[192:195], v214 offset:1024
    ds_read_b128 v[196:199], v214 offset:1088
    ds_read_b128 v[200:203], v214 offset:1152
    ds_read_b128 v[204:207], v214 offset:1216
    s_waitcnt lgkmcnt(0)
    s_barrier
    v_mov_b32 v171, v211
    s_lshl_b32 m0, s62, 13
    v_xor_b32 v221, 64, v213
    v_xor_b32 v222, 128, v213
    v_xor_b32 v223, 192, v213
    buffer_load_dwordx4 v213, s[20:23], s3 offen offset:0 nt lds
    buffer_load_dwordx4 v221, s[20:23], s3 offen offset:1024 nt lds
    buffer_load_dwordx4 v222, s[20:23], s3 offen offset:2048 nt lds
    buffer_load_dwordx4 v223, s[20:23], s3 offen offset:3072 nt lds
    v_mfma_f32_16x16x32_bf16 v[224:227], v[16:19], v[192:195], 0
    v_mfma_f32_16x16x32_bf16 v[224:227], v[20:23], v[196:199], v[224:227]
    v_mfma_f32_16x16x32_bf16 v[224:227], v[24:27], v[200:203], v[224:227]
    v_mfma_f32_16x16x32_bf16 v[224:227], v[28:31], v[204:207], v[224:227]
    v_mfma_f32_16x16x32_bf16 v[228:231], v[32:35], v[192:195], 0
    v_mfma_f32_16x16x32_bf16 v[228:231], v[36:39], v[196:199], v[228:231]
    v_mfma_f32_16x16x32_bf16 v[228:231], v[40:43], v[200:203], v[228:231]
    v_mfma_f32_16x16x32_bf16 v[228:231], v[44:47], v[204:207], v[228:231]
    v_mfma_f32_16x16x32_bf16 v[232:235], v[48:51], v[192:195], 0
    v_mfma_f32_16x16x32_bf16 v[232:235], v[52:55], v[196:199], v[232:235]
    v_mfma_f32_16x16x32_bf16 v[232:235], v[56:59], v[200:203], v[232:235]
    v_mfma_f32_16x16x32_bf16 v[232:235], v[60:63], v[204:207], v[232:235]
    v_mfma_f32_16x16x32_bf16 v[236:239], v[64:67], v[192:195], 0
    v_mfma_f32_16x16x32_bf16 v[236:239], v[68:71], v[196:199], v[236:239]
    v_mfma_f32_16x16x32_bf16 v[236:239], v[72:75], v[200:203], v[236:239]
    v_mfma_f32_16x16x32_bf16 v[236:239], v[76:79], v[204:207], v[236:239]
    v_mov_b32 v167, v213
    s_nop 7
    v_max3_f32 v246, v224, v225, v226
    v_max3_f32 v246, v246, v227, v228
    v_max3_f32 v246, v246, v229, v230
    v_max3_f32 v246, v246, v231, v232
    v_max3_f32 v246, v246, v233, v234
    v_max3_f32 v246, v246, v235, v236
    v_max3_f32 v246, v246, v237, v238
    v_max_f32 v246, v246, v239
    v_mov_b32 v247, v246
    s_nop 1
    v_permlane16_swap_b32 v246, v247
    v_max_f32 v246, v246, v247
    v_mov_b32 v247, v246
    s_nop 1
    v_permlane32_swap_b32 v246, v247
    v_max_f32 v246, v246, v247
    v_mul_f32 v246, s52, v246
    v_pk_fma_f32 v[224:225], v[224:225], s[52:53], v[246:247] op_sel_hi:[1,1,0] neg_lo:[0,0,1] neg_hi:[0,0,1]
    v_pk_fma_f32 v[226:227], v[226:227], s[52:53], v[246:247] op_sel_hi:[1,1,0] neg_lo:[0,0,1] neg_hi:[0,0,1]
    v_pk_fma_f32 v[228:229], v[228:229], s[52:53], v[246:247] op_sel_hi:[1,1,0] neg_lo:[0,0,1] neg_hi:[0,0,1]
    v_pk_fma_f32 v[230:231], v[230:231], s[52:53], v[246:247] op_sel_hi:[1,1,0] neg_lo:[0,0,1] neg_hi:[0,0,1]
    v_pk_fma_f32 v[232:233], v[232:233], s[52:53], v[246:247] op_sel_hi:[1,1,0] neg_lo:[0,0,1] neg_hi:[0,0,1]
    v_pk_fma_f32 v[234:235], v[234:235], s[52:53], v[246:247] op_sel_hi:[1,1,0] neg_lo:[0,0,1] neg_hi:[0,0,1]
    v_pk_fma_f32 v[236:237], v[236:237], s[52:53], v[246:247] op_sel_hi:[1,1,0] neg_lo:[0,0,1] neg_hi:[0,0,1]
    v_pk_fma_f32 v[238:239], v[238:239], s[52:53], v[246:247] op_sel_hi:[1,1,0] neg_lo:[0,0,1] neg_hi:[0,0,1]
    v_exp_f32 v224, v224
    v_exp_f32 v225, v225
    v_exp_f32 v226, v226
    v_exp_f32 v227, v227
    v_exp_f32 v228, v228
    v_exp_f32 v229, v229
    v_exp_f32 v230, v230
    v_exp_f32 v231, v231
    v_exp_f32 v232, v232
    v_exp_f32 v233, v233
    v_exp_f32 v234, v234
    v_exp_f32 v235, v235
    v_exp_f32 v236, v236
    v_exp_f32 v237, v237
    v_exp_f32 v238, v238
    v_exp_f32 v239, v239
    s_nop 0
    v_add_f32 v247, v224, v225
    v_add_f32 v247, v247, v226
    v_add_f32 v247, v247, v227
    v_add_f32 v247, v247, v228
    v_add_f32 v247, v247, v229
    v_add_f32 v247, v247, v230
    v_add_f32 v247, v247, v231
    v_add_f32 v247, v247, v232
    v_add_f32 v247, v247, v233
    v_add_f32 v247, v247, v234
    v_add_f32 v247, v247, v235
    v_add_f32 v247, v247, v236
    v_add_f32 v247, v247, v237
    v_add_f32 v247, v247, v238
    v_add_f32 v247, v247, v239
    v_cvt_pk_bf16_f32 v224, v224, v225
    v_cvt_pk_bf16_f32 v225, v226, v227
    v_cvt_pk_bf16_f32 v226, v228, v229
    v_cvt_pk_bf16_f32 v227, v230, v231
    v_cvt_pk_bf16_f32 v228, v232, v233
    v_cvt_pk_bf16_f32 v229, v234, v235
    v_cvt_pk_bf16_f32 v230, v236, v237
    v_cvt_pk_bf16_f32 v231, v238, v239
    v_mov_b32 v11, v247
    s_nop 1
    v_permlane16_swap_b32 v247, v11
    v_add_f32 v247, v247, v11
    v_mov_b32 v11, v247
    s_nop 1
    v_permlane32_swap_b32 v247, v11
    v_add_f32 v247, v247, v11
    ds_write_b64 v215, v[246:247]
    v_mbcnt_lo_u32_b32 v11, -1, 0
    s_lshl_b32 s47, s40, 10
    s_add_u32 s47, s47, 158976
    v_lshl_add_u32 v11, v11, 3, s47
    s_waitcnt vmcnt(4) lgkmcnt(0)
    s_barrier
    ds_read_b64_tr_b16 v[144:145], v0 offset:8192
    ds_read_b64_tr_b16 v[146:147], v0 offset:12288
    ds_read_b64_tr_b16 v[148:149], v1 offset:8192
    ds_read_b64_tr_b16 v[150:151], v1 offset:12288
    ds_read_b64_tr_b16 v[152:153], v2 offset:8192
    ds_read_b64_tr_b16 v[154:155], v2 offset:12288
    ds_read_b64_tr_b16 v[156:157], v3 offset:8192
    ds_read_b64_tr_b16 v[158:159], v3 offset:12288
    ds_read_b64_tr_b16 v[232:233], v4 offset:8192
    ds_read_b64_tr_b16 v[234:235], v4 offset:12288
    ds_read_b64_tr_b16 v[236:237], v5 offset:8192
    ds_read_b64_tr_b16 v[238:239], v5 offset:12288
    ds_read_b64_tr_b16 v[240:241], v6 offset:8192
    ds_read_b64_tr_b16 v[242:243], v6 offset:12288
    ds_read_b64_tr_b16 v[244:245], v7 offset:8192
    ds_read_b64_tr_b16 v[246:247], v7 offset:12288
    s_waitcnt lgkmcnt(14)
    v_mfma_f32_16x16x32_bf16 v[144:147], v[228:231], v[144:147], 0
    ds_read_b64_tr_b16 v[196:197], v0 offset:0
    ds_read_b64_tr_b16 v[198:199], v0 offset:4096
    s_waitcnt lgkmcnt(14)
    v_mfma_f32_16x16x32_bf16 v[148:151], v[228:231], v[148:151], 0
    ds_read_b64_tr_b16 v[200:201], v1 offset:0
    ds_read_b64_tr_b16 v[202:203], v1 offset:4096
    s_waitcnt lgkmcnt(14)
    v_mfma_f32_16x16x32_bf16 v[152:155], v[228:231], v[152:155], 0
    ds_read_b64_tr_b16 v[204:205], v2 offset:0
    ds_read_b64_tr_b16 v[206:207], v2 offset:4096
    s_waitcnt lgkmcnt(14)
    v_mfma_f32_16x16x32_bf16 v[156:159], v[228:231], v[156:159], 0
    ds_read_b64_tr_b16 v[208:209], v3 offset:0
    ds_read_b64_tr_b16 v[210:211], v3 offset:4096
    s_waitcnt lgkmcnt(14)
    v_mfma_f32_16x16x32_bf16 v[232:235], v[228:231], v[232:235], 0
    ds_read_b64_tr_b16 v[212:213], v4 offset:0
    ds_read_b64_tr_b16 v[214:215], v4 offset:4096
    s_waitcnt lgkmcnt(14)
    v_mfma_f32_16x16x32_bf16 v[236:239], v[228:231], v[236:239], 0
    ds_read_b64_tr_b16 v[216:217], v5 offset:0
    ds_read_b64_tr_b16 v[218:219], v5 offset:4096
    s_waitcnt lgkmcnt(14)
    v_mfma_f32_16x16x32_bf16 v[240:243], v[228:231], v[240:243], 0
    ds_read_b64_tr_b16 v[220:221], v6 offset:0
    ds_read_b64_tr_b16 v[222:223], v6 offset:4096
    s_waitcnt lgkmcnt(14)
    v_mfma_f32_16x16x32_bf16 v[244:247], v[228:231], v[244:247], 0
    ds_read_b64_tr_b16 v[12:13], v7 offset:0
    ds_read_b64_tr_b16 v[14:15], v7 offset:4096
    s_waitcnt lgkmcnt(14)
    v_mfma_f32_16x16x32_bf16 v[144:147], v[224:227], v[196:199], v[144:147]
    s_waitcnt lgkmcnt(12)
    v_mfma_f32_16x16x32_bf16 v[148:151], v[224:227], v[200:203], v[148:151]
    s_waitcnt lgkmcnt(10)
    v_mfma_f32_16x16x32_bf16 v[152:155], v[224:227], v[204:207], v[152:155]
    s_waitcnt lgkmcnt(8)
    v_mfma_f32_16x16x32_bf16 v[156:159], v[224:227], v[208:211], v[156:159]
    s_waitcnt lgkmcnt(6)
    v_mfma_f32_16x16x32_bf16 v[232:235], v[224:227], v[212:215], v[232:235]
    s_waitcnt lgkmcnt(4)
    v_mfma_f32_16x16x32_bf16 v[236:239], v[224:227], v[216:219], v[236:239]
    s_waitcnt lgkmcnt(2)
    v_mfma_f32_16x16x32_bf16 v[240:243], v[224:227], v[220:223], v[240:243]
    s_waitcnt lgkmcnt(0)
    v_mfma_f32_16x16x32_bf16 v[244:247], v[224:227], v[12:15], v[244:247]
    s_mov_b64 exec, 1
    v_mov_b32 v224, 158848
    v_mov_b32 v225, 1
    s_mov_b64 exec, 0xffff
    ds_write_b64 v11, v[144:145] offset:0
    ds_write_b64 v11, v[148:149] offset:128
    ds_write_b64 v11, v[152:153] offset:256
    ds_write_b64 v11, v[156:157] offset:384
    ds_write_b64 v11, v[232:233] offset:512
    ds_write_b64 v11, v[236:237] offset:640
    ds_write_b64 v11, v[240:241] offset:768
    ds_write_b64 v11, v[244:245] offset:896
    s_mov_b64 exec, 1
    ds_add_u32 v224, v225
    s_mov_b64 exec, -1
    s_lshl_b32 s47, s62, 13
    s_add_u32 m0, s47, 0x1000
    v_xor_b32 v226, 64, v167
    v_xor_b32 v227, 128, v167
    v_xor_b32 v228, 192, v167
    buffer_load_dwordx4 v167, s[20:23], s41 offen offset:0 nt lds
    buffer_load_dwordx4 v226, s[20:23], s41 offen offset:1024 nt lds
    buffer_load_dwordx4 v227, s[20:23], s41 offen offset:2048 nt lds
    buffer_load_dwordx4 v228, s[20:23], s41 offen offset:3072 nt lds
    v_mov_b32 v167, 0
L_gdone:
    s_cmp_eq_u32 s40, 3
    s_cbranch_scc1 L_reduce
    s_cmp_eq_u32 s58, 0
    s_cbranch_scc1 L_noflag
    v_mov_b32 v11, 158852
    ds_read_b32 v11, v11
    s_waitcnt lgkmcnt(0)
    v_readfirstlane_b32 s63, v11
L_noflag:
    s_waitcnt vmcnt(4)
    s_branch L_tileA
L_reduce:
    v_mbcnt_lo_u32_b32 v224, -1, 0
    v_mbcnt_hi_u32_b32 v224, -1, v224
    v_lshrrev_b32 v225, 5, v224
    v_and_b32 v227, 31, v224
    v_lshlrev_b32 v227, 5, v227
    v_lshl_add_u32 v227, v225, 2, v227
    v_add_u32 v227, 158976, v227
    v_lshlrev_b32 v225, 3, v225
    v_add_u32 v225, 158720, v225
    v_lshlrev_b32 v224, 4, v224
    v_mov_b32 v226, 158848
    s_mov_b32 s59, 0
L_lspin:
    ds_read_b64 v[228:229], v226
    s_add_u32 s59, s59, 1
    s_waitcnt lgkmcnt(0)
    v_readfirstlane_b32 s47, v228
    v_readfirstlane_b32 s63, v229
    s_cmp_ge_u32 s59, 0x100000
    s_cbranch_scc1 L_lok
    s_cmp_lt_u32 s47, 4
    s_cbranch_scc1 L_lspin
L_lok:
    ds_read_b64 v[228:229], v225 offset:0
    ds_read_b64 v[230:231], v225 offset:16
    ds_read_b64 v[192:193], v225 offset:32
    ds_read_b64 v[194:195], v225 offset:48
    ds_read2_b32 v[232:233], v227 offset0:0 offset1:2
    ds_read2_b32 v[234:235], v227 offset0:4 offset1:6
    v_add_u32 v227, 1024, v227
    ds_read2_b32 v[236:237], v227 offset0:0 offset1:2
    ds_read2_b32 v[238:239], v227 offset0:4 offset1:6
    v_add_u32 v227, 1024, v227
    ds_read2_b32 v[240:241], v227 offset0:0 offset1:2
    ds_read2_b32 v[242:243], v227 offset0:4 offset1:6
    v_add_u32 v227, 1024, v227
    ds_read2_b32 v[244:245], v227 offset0:0 offset1:2
    ds_read2_b32 v[246:247], v227 offset0:4 offset1:6
    s_waitcnt lgkmcnt(0)
    v_max3_f32 v225, v228, v230, v192
    v_max_f32 v225, v225, v194
    v_sub_f32 v228, v228, v225
    v_sub_f32 v230, v230, v225
    v_sub_f32 v192, v192, v225
    v_sub_f32 v194, v194, v225
    v_exp_f32 v228, v228
    v_exp_f32 v230, v230
    v_exp_f32 v192, v192
    v_exp_f32 v194, v194
    s_nop 0
    v_mul_f32 v232, v232, v228
    v_mul_f32 v233, v233, v228
    v_mul_f32 v234, v234, v228
    v_mul_f32 v235, v235, v228
    v_mul_f32 v229, v229, v228
    v_fmac_f32 v232, v236, v230
    v_fmac_f32 v233, v237, v230
    v_fmac_f32 v234, v238, v230
    v_fmac_f32 v235, v239, v230
    v_fmac_f32 v229, v231, v230
    v_fmac_f32 v232, v240, v192
    v_fmac_f32 v233, v241, v192
    v_fmac_f32 v234, v242, v192
    v_fmac_f32 v235, v243, v192
    v_fmac_f32 v229, v193, v192
    v_fmac_f32 v232, v244, v194
    v_fmac_f32 v233, v245, v194
    v_fmac_f32 v234, v246, v194
    v_fmac_f32 v235, v247, v194
    v_fmac_f32 v229, v195, v194
    v_mov_b32 v236, v235
    v_mov_b32 v237, v225
    v_mov_b32 v238, v229
    v_mov_b32 v239, s63
    v_mov_b32 v235, s63
    buffer_store_dwordx4 v[236:239], v224, s[36:39], s42 offen offset:1024 sc0 sc1
    buffer_store_dwordx4 v[232:235], v224, s[36:39], s42 offen sc0 sc1
    s_cmp_lg_u32 s63, 0
    s_cbranch_scc1 L_tagged
    s_waitcnt vmcnt(0)
    s_lshl_b32 s47, s43, 3
    s_lshl_b32 s48, 1, s44
    v_mov_b32 v224, s47
    v_mov_b32 v225, s48
    s_mov_b64 exec, 1
    global_atomic_or v224, v225, s[16:17] offset:4 sc1
    s_mov_b64 exec, -1
L_tagged:
    s_waitcnt vmcnt(6)
L_tileA:
    v_xor_b32 v237, 64, v171
    v_xor_b32 v238, 128, v171
    v_xor_b32 v239, 192, v171
    ds_read_b128 v[128:131], v171 offset:0
    ds_read_b128 v[132:135], v237 offset:0
    ds_read_b128 v[136:139], v238 offset:0
    ds_read_b128 v[140:143], v239 offset:0
    s_cmp_lg_u32 s40, 4
    s_cbranch_scc1 L_nohalo2
    v_add_u32 v236, 65536, v171
    v_add_u32 v237, 65536, v237
    v_add_u32 v238, 65536, v238
    v_add_u32 v239, 65536, v239
    ds_read_b128 v[16:19], v236 offset:0
    ds_read_b128 v[20:23], v237 offset:0
    ds_read_b128 v[24:27], v238 offset:0
    ds_read_b128 v[28:31], v239 offset:0
    ds_read_b128 v[32:35], v236 offset:4096
    ds_read_b128 v[36:39], v237 offset:4096
    ds_read_b128 v[40:43], v238 offset:4096
    ds_read_b128 v[44:47], v239 offset:4096
L_nohalo2:
    s_waitcnt lgkmcnt(0)
    s_sub_u32 s47, s51, 48
    s_cmp_lt_u32 s47, 1968
    s_cbranch_scc1 L_fastA
    ds_read_b64_tr_b16 v[160:161], v0 offset:16384
    ds_read_b64_tr_b16 v[164:165], v1 offset:16384
    ds_read_b64_tr_b16 v[168:169], v2 offset:16384
    ds_read_b64_tr_b16 v[172:173], v3 offset:16384
    ds_read_b64_tr_b16 v[176:177], v4 offset:16384
    ds_read_b64_tr_b16 v[180:181], v5 offset:16384
    ds_read_b64_tr_b16 v[184:185], v6 offset:16384
    ds_read_b64_tr_b16 v[188:189], v7 offset:16384
    v_mfma_f32_16x16x32_bf16 v[244:247], v[112:115], v[128:131], 0
    v_mfma_f32_16x16x32_bf16 v[244:247], v[116:119], v[132:135], v[244:247]
    v_mfma_f32_16x16x32_bf16 v[244:247], v[120:123], v[136:139], v[244:247]
    v_mfma_f32_16x16x32_bf16 v[244:247], v[124:127], v[140:143], v[244:247]
    v_mfma_f32_16x16x32_bf16 v[224:227], v[16:19], v[128:131], v[248:251]
    v_mfma_f32_16x16x32_bf16 v[224:227], v[20:23], v[132:135], v[224:227]
    v_mfma_f32_16x16x32_bf16 v[224:227], v[24:27], v[136:139], v[224:227]
    v_mfma_f32_16x16x32_bf16 v[224:227], v[28:31], v[140:143], v[224:227]
    v_mfma_f32_16x16x32_bf16 v[228:231], v[32:35], v[128:131], 0
    v_mfma_f32_16x16x32_bf16 v[228:231], v[36:39], v[132:135], v[228:231]
    v_mfma_f32_16x16x32_bf16 v[228:231], v[40:43], v[136:139], v[228:231]
    v_mfma_f32_16x16x32_bf16 v[228:231], v[44:47], v[140:143], v[228:231]
    v_mfma_f32_16x16x32_bf16 v[232:235], v[48:51], v[128:131], 0
    v_mfma_f32_16x16x32_bf16 v[232:235], v[52:55], v[132:135], v[232:235]
    v_mfma_f32_16x16x32_bf16 v[232:235], v[56:59], v[136:139], v[232:235]
    v_mfma_f32_16x16x32_bf16 v[232:235], v[60:63], v[140:143], v[232:235]
    v_mfma_f32_16x16x32_bf16 v[236:239], v[64:67], v[128:131], 0
    v_mfma_f32_16x16x32_bf16 v[236:239], v[68:71], v[132:135], v[236:239]
    v_mfma_f32_16x16x32_bf16 v[236:239], v[72:75], v[136:139], v[236:239]
    v_mfma_f32_16x16x32_bf16 v[236:239], v[76:79], v[140:143], v[236:239]
    v_mfma_f32_16x16x32_bf16 v[240:243], v[80:83], v[128:131], v[252:255]
    v_mfma_f32_16x16x32_bf16 v[240:243], v[84:87], v[132:135], v[240:243]
    v_mfma_f32_16x16x32_bf16 v[240:243], v[88:91], v[136:139], v[240:243]
    v_mfma_f32_16x16x32_bf16 v[240:243], v[92:95], v[140:143], v[240:243]
    ds_read_b64_tr_b16 v[16:17], v0 offset:8192
    ds_read_b64_tr_b16 v[18:19], v0 offset:12288
    ds_read_b64_tr_b16 v[20:21], v1 offset:8192
    ds_read_b64_tr_b16 v[22:23], v1 offset:12288
    ds_read_b64_tr_b16 v[24:25], v2 offset:8192
    ds_read_b64_tr_b16 v[26:27], v2 offset:12288
    ds_read_b64_tr_b16 v[28:29], v3 offset:8192
    ds_read_b64_tr_b16 v[30:31], v3 offset:12288
    ds_read_b64_tr_b16 v[128:129], v4 offset:8192
    ds_read_b64_tr_b16 v[130:131], v4 offset:12288
    ds_read_b64_tr_b16 v[132:133], v5 offset:8192
    ds_read_b64_tr_b16 v[134:135], v5 offset:12288
    ds_read_b64_tr_b16 v[136:137], v6 offset:8192
    ds_read_b64_tr_b16 v[138:139], v6 offset:12288
    ds_read_b64_tr_b16 v[140:141], v7 offset:8192
    ds_read_b64_tr_b16 v[142:143], v7 offset:12288
    v_mbcnt_lo_u32_b32 v11, -1, 0
    v_mbcnt_hi_u32_b32 v11, -1, v11
    v_lshrrev_b32 v11, 4, v11
    s_sub_u32 s47, s51, 34
    s_movk_i32 s48, 2046
    v_lshl_add_u32 v11, v11, 2, s47
    v_mov_b32 v246, 0xff000000
    s_nop 3
    v_add_u32 v247, 0, v11
    v_cmp_gt_u32 vcc, s48, v247
    s_nop 1
    v_cndmask_b32 v224, v246, v224, vcc
    v_add_u32 v247, 1, v11
    v_cmp_gt_u32 vcc, s48, v247
    s_nop 1
    v_cndmask_b32 v225, v246, v225, vcc
    v_add_u32 v247, 2, v11
    v_cmp_gt_u32 vcc, s48, v247
    s_nop 1
    v_cndmask_b32 v226, v246, v226, vcc
    v_add_u32 v247, 3, v11
    v_cmp_gt_u32 vcc, s48, v247
    s_nop 1
    v_cndmask_b32 v227, v246, v227, vcc
    v_add_u32 v247, 16, v11
    v_cmp_gt_u32 vcc, s48, v247
    s_nop 1
    v_cndmask_b32 v228, v246, v228, vcc
    v_add_u32 v247, 17, v11
    v_cmp_gt_u32 vcc, s48, v247
    s_nop 1
    v_cndmask_b32 v229, v246, v229, vcc
    v_add_u32 v247, 18, v11
    v_cmp_gt_u32 vcc, s48, v247
    s_nop 1
    v_cndmask_b32 v230, v246, v230, vcc
    v_add_u32 v247, 19, v11
    v_cmp_gt_u32 vcc, s48, v247
    s_nop 1
    v_cndmask_b32 v231, v246, v231, vcc
    v_add_u32 v247, 32, v11
    v_cmp_gt_u32 vcc, s48, v247
    s_nop 1
    v_cndmask_b32 v232, v246, v232, vcc
    v_add_u32 v247, 33, v11
    v_cmp_gt_u32 vcc, s48, v247
    s_nop 1
    v_cndmask_b32 v233, v246, v233, vcc
    v_add_u32 v247, 34, v11
    v_cmp_gt_u32 vcc, s48, v247
    s_nop 1
    v_cndmask_b32 v234, v246, v234, vcc
    v_add_u32 v247, 35, v11
    v_cmp_gt_u32 vcc, s48, v247
    s_nop 1
    v_cndmask_b32 v235, v246, v235, vcc
    v_add_u32 v247, 48, v11
    v_cmp_gt_u32 vcc, s48, v247
    s_nop 1
    v_cndmask_b32 v236, v246, v236, vcc
    v_add_u32 v247, 49, v11
    v_cmp_gt_u32 vcc, s48, v247
    s_nop 1
    v_cndmask_b32 v237, v246, v237, vcc
    v_add_u32 v247, 50, v11
    v_cmp_gt_u32 vcc, s48, v247
    s_nop 1
    v_cndmask_b32 v238, v246, v238, vcc
    v_add_u32 v247, 51, v11
    v_cmp_gt_u32 vcc, s48, v247
    s_nop 1
    v_cndmask_b32 v239, v246, v239, vcc
    v_add_u32 v247, 64, v11
    v_cmp_gt_u32 vcc, s48, v247
    s_nop 1
    v_cndmask_b32 v240, v246, v240, vcc
    v_add_u32 v247, 65, v11
    v_cmp_gt_u32 vcc, s48, v247
    s_nop 1
    v_cndmask_b32 v241, v246, v241, vcc
    v_add_u32 v247, 66, v11
    v_cmp_gt_u32 vcc, s48, v247
    s_nop 1
    v_cndmask_b32 v242, v246, v242, vcc
    v_add_u32 v247, 67, v11
    v_cmp_gt_u32 vcc, s48, v247
    s_nop 1
    v_cndmask_b32 v243, v246, v243, vcc
    v_max3_f32 v246, v224, v225, v226
    v_max3_f32 v246, v246, v227, v228
    v_max3_f32 v246, v246, v229, v230
    v_max3_f32 v246, v246, v231, v232
    v_max3_f32 v246, v246, v233, v234
    v_max3_f32 v246, v246, v235, v236
    v_max3_f32 v246, v246, v237, v238
    v_max3_f32 v246, v246, v239, v240
    v_max3_f32 v246, v246, v241, v242
    v_max3_f32 v246, v246, v243, v244
    v_max_f32 v246, v246, v245
    s_branch L_joinA
L_fastA:
    v_mfma_f32_16x16x32_bf16 v[224:227], v[16:19], v[128:131], v[248:251]
    ds_read_b64_tr_b16 v[160:161], v0 offset:16384
    v_mfma_f32_16x16x32_bf16 v[224:227], v[20:23], v[132:135], v[224:227]
    ds_read_b64_tr_b16 v[164:165], v1 offset:16384
    v_mfma_f32_16x16x32_bf16 v[224:227], v[24:27], v[136:139], v[224:227]
    ds_read_b64_tr_b16 v[168:169], v2 offset:16384
    v_mfma_f32_16x16x32_bf16 v[224:227], v[28:31], v[140:143], v[224:227]
    ds_read_b64_tr_b16 v[172:173], v3 offset:16384
    v_mfma_f32_16x16x32_bf16 v[244:247], v[112:115], v[128:131], 0
    ds_read_b64_tr_b16 v[176:177], v4 offset:16384
    v_mfma_f32_16x16x32_bf16 v[244:247], v[116:119], v[132:135], v[244:247]
    ds_read_b64_tr_b16 v[180:181], v5 offset:16384
    v_mfma_f32_16x16x32_bf16 v[244:247], v[120:123], v[136:139], v[244:247]
    ds_read_b64_tr_b16 v[184:185], v6 offset:16384
    v_mfma_f32_16x16x32_bf16 v[244:247], v[124:127], v[140:143], v[244:247]
    ds_read_b64_tr_b16 v[188:189], v7 offset:16384
    v_mfma_f32_16x16x32_bf16 v[228:231], v[32:35], v[128:131], 0
    ds_read_b64_tr_b16 v[16:17], v0 offset:8192
    v_mfma_f32_16x16x32_bf16 v[228:231], v[36:39], v[132:135], v[228:231]
    ds_read_b64_tr_b16 v[18:19], v0 offset:12288
    v_mfma_f32_16x16x32_bf16 v[228:231], v[40:43], v[136:139], v[228:231]
    ds_read_b64_tr_b16 v[20:21], v1 offset:8192
    v_mfma_f32_16x16x32_bf16 v[228:231], v[44:47], v[140:143], v[228:231]
    ds_read_b64_tr_b16 v[22:23], v1 offset:12288
    v_mfma_f32_16x16x32_bf16 v[232:235], v[48:51], v[128:131], 0
    ds_read_b64_tr_b16 v[24:25], v2 offset:8192
    v_mfma_f32_16x16x32_bf16 v[232:235], v[52:55], v[132:135], v[232:235]
    ds_read_b64_tr_b16 v[26:27], v2 offset:12288
    v_mfma_f32_16x16x32_bf16 v[232:235], v[56:59], v[136:139], v[232:235]
    ds_read_b64_tr_b16 v[28:29], v3 offset:8192
    v_mfma_f32_16x16x32_bf16 v[232:235], v[60:63], v[140:143], v[232:235]
    ds_read_b64_tr_b16 v[30:31], v3 offset:12288
    v_mfma_f32_16x16x32_bf16 v[236:239], v[64:67], v[128:131], 0
    v_max3_f32 v246, v244, v245, v224
    v_mfma_f32_16x16x32_bf16 v[236:239], v[68:71], v[132:135], v[236:239]
    v_max3_f32 v246, v246, v225, v226
    v_mfma_f32_16x16x32_bf16 v[236:239], v[72:75], v[136:139], v[236:239]
    v_max3_f32 v246, v246, v227, v228
    v_mfma_f32_16x16x32_bf16 v[236:239], v[76:79], v[140:143], v[236:239]
    v_max3_f32 v246, v246, v229, v230
    v_mfma_f32_16x16x32_bf16 v[240:243], v[80:83], v[128:131], v[252:255]
    v_max3_f32 v246, v246, v231, v232
    v_mfma_f32_16x16x32_bf16 v[240:243], v[84:87], v[132:135], v[240:243]
    v_max3_f32 v246, v246, v233, v234
    v_mfma_f32_16x16x32_bf16 v[240:243], v[88:91], v[136:139], v[240:243]
    v_mfma_f32_16x16x32_bf16 v[240:243], v[92:95], v[140:143], v[240:243]
    ds_read_b64_tr_b16 v[128:129], v4 offset:8192
    ds_read_b64_tr_b16 v[130:131], v4 offset:12288
    ds_read_b64_tr_b16 v[132:133], v5 offset:8192
    v_max3_f32 v246, v246, v235, v236
    ds_read_b64_tr_b16 v[134:135], v5 offset:12288
    ds_read_b64_tr_b16 v[136:137], v6 offset:8192
    v_max3_f32 v246, v246, v237, v238
    v_max_f32 v246, v246, v239
    ds_read_b64_tr_b16 v[138:139], v6 offset:12288
    ds_read_b64_tr_b16 v[140:141], v7 offset:8192
    ds_read_b64_tr_b16 v[142:143], v7 offset:12288
    v_max3_f32 v246, v246, v240, v241
    v_max3_f32 v246, v246, v242, v243
L_joinA:
    v_mov_b32 v247, v246
    s_nop 1
    v_permlane16_swap_b32 v246, v247
    v_max_f32 v246, v246, v247
    v_mov_b32 v247, v246
    s_nop 1
    v_permlane32_swap_b32 v246, v247
    v_max_f32 v246, v246, v247
    v_mul_f32 v246, s52, v246
    v_pk_fma_f32 v[224:225], v[224:225], s[52:53], v[246:247] op_sel_hi:[1,1,0] neg_lo:[0,0,1] neg_hi:[0,0,1]
    v_pk_fma_f32 v[226:227], v[226:227], s[52:53], v[246:247] op_sel_hi:[1,1,0] neg_lo:[0,0,1] neg_hi:[0,0,1]
    v_pk_fma_f32 v[228:229], v[228:229], s[52:53], v[246:247] op_sel_hi:[1,1,0] neg_lo:[0,0,1] neg_hi:[0,0,1]
    v_pk_fma_f32 v[230:231], v[230:231], s[52:53], v[246:247] op_sel_hi:[1,1,0] neg_lo:[0,0,1] neg_hi:[0,0,1]
    v_exp_f32 v224, v224
    v_exp_f32 v225, v225
    v_exp_f32 v226, v226
    v_exp_f32 v227, v227
    v_exp_f32 v228, v228
    v_exp_f32 v229, v229
    v_exp_f32 v230, v230
    v_exp_f32 v231, v231
    v_pk_fma_f32 v[240:241], v[240:241], s[52:53], v[246:247] op_sel_hi:[1,1,0] neg_lo:[0,0,1] neg_hi:[0,0,1]
    v_cvt_pk_bf16_f32 v224, v224, v225
    v_cvt_pk_bf16_f32 v225, v226, v227
    v_cvt_pk_bf16_f32 v226, v228, v229
    v_cvt_pk_bf16_f32 v227, v230, v231
    v_pk_fma_f32 v[242:243], v[242:243], s[52:53], v[246:247] op_sel_hi:[1,1,0] neg_lo:[0,0,1] neg_hi:[0,0,1]
    s_waitcnt lgkmcnt(8)
    v_mfma_f32_16x16x32_bf16 v[192:195], v[196:199], v[224:227], 0
    v_pk_fma_f32 v[244:245], v[244:245], s[52:53], v[246:247] op_sel_hi:[1,1,0] neg_lo:[0,0,1] neg_hi:[0,0,1]
    v_exp_f32 v240, v240
    v_mfma_f32_16x16x32_bf16 v[196:199], v[200:203], v[224:227], 0
    v_exp_f32 v241, v241
    v_exp_f32 v242, v242
    v_mfma_f32_16x16x32_bf16 v[200:203], v[204:207], v[224:227], 0
    v_exp_f32 v243, v243
    v_exp_f32 v244, v244
    v_mfma_f32_16x16x32_bf16 v[204:207], v[208:211], v[224:227], 0
    v_exp_f32 v245, v245
    v_mov_b32 v228, 0x3f803f80
    v_mfma_f32_16x16x32_bf16 v[208:211], v[212:215], v[224:227], 0
    v_mov_b32 v229, 0x3f803f80
    v_mov_b32 v230, 0x3f803f80
    v_mfma_f32_16x16x32_bf16 v[212:215], v[216:219], v[224:227], 0
    v_mov_b32 v231, 0x3f803f80
    v_cvt_pk_bf16_f32 v240, v240, v241
    v_mfma_f32_16x16x32_bf16 v[216:219], v[220:223], v[224:227], 0
    v_cvt_pk_bf16_f32 v241, v242, v243
    v_cvt_pk_bf16_f32 v242, v244, v245
    v_mfma_f32_16x16x32_bf16 v[220:223], v[12:15], v[224:227], 0
    v_mov_b32 v243, 0
    v_cndmask_b32 v242, 0, v242, s[54:55]
    v_pk_fma_f32 v[232:233], v[232:233], s[52:53], v[246:247] op_sel_hi:[1,1,0] neg_lo:[0,0,1] neg_hi:[0,0,1]
    v_pk_fma_f32 v[234:235], v[234:235], s[52:53], v[246:247] op_sel_hi:[1,1,0] neg_lo:[0,0,1] neg_hi:[0,0,1]
    v_mfma_f32_16x16x32_bf16 v[192:195], v[160:163], v[240:243], v[192:195]
    v_pk_fma_f32 v[236:237], v[236:237], s[52:53], v[246:247] op_sel_hi:[1,1,0] neg_lo:[0,0,1] neg_hi:[0,0,1]
    v_pk_fma_f32 v[238:239], v[238:239], s[52:53], v[246:247] op_sel_hi:[1,1,0] neg_lo:[0,0,1] neg_hi:[0,0,1]
    v_mfma_f32_16x16x32_bf16 v[196:199], v[164:167], v[240:243], v[196:199]
    v_exp_f32 v232, v232
    v_exp_f32 v233, v233
    v_mfma_f32_16x16x32_bf16 v[200:203], v[168:171], v[240:243], v[200:203]
    v_exp_f32 v234, v234
    v_exp_f32 v235, v235
    v_mfma_f32_16x16x32_bf16 v[204:207], v[172:175], v[240:243], v[204:207]
    v_exp_f32 v236, v236
    v_exp_f32 v237, v237
    v_mfma_f32_16x16x32_bf16 v[208:211], v[176:179], v[240:243], v[208:211]
    v_exp_f32 v238, v238
    v_exp_f32 v239, v239
    v_mfma_f32_16x16x32_bf16 v[212:215], v[180:183], v[240:243], v[212:215]
    v_mov_b32 v11, 0
    v_cvt_pk_bf16_f32 v232, v232, v233
    v_mfma_f32_16x16x32_bf16 v[216:219], v[184:187], v[240:243], v[216:219]
    v_cvt_pk_bf16_f32 v233, v234, v235
    v_cvt_pk_bf16_f32 v234, v236, v237
    v_mfma_f32_16x16x32_bf16 v[220:223], v[188:191], v[240:243], v[220:223]
    v_cvt_pk_bf16_f32 v235, v238, v239
    v_mfma_f32_16x16x32_bf16 v[244:247], v[228:231], v[224:227], 0
    v_mfma_f32_16x16x32_bf16 v[244:247], v[228:231], v[240:243], v[244:247]
    v_mfma_f32_16x16x32_bf16 v[244:247], v[228:231], v[232:235], v[244:247]
    s_waitcnt lgkmcnt(0)
    v_mfma_f32_16x16x32_bf16 v[192:195], v[16:19], v[232:235], v[192:195]
    ds_read_b64_tr_b16 v[160:161], v0 offset:4096
    v_mfma_f32_16x16x32_bf16 v[196:199], v[20:23], v[232:235], v[196:199]
    ds_read_b64_tr_b16 v[164:165], v1 offset:4096
    v_mfma_f32_16x16x32_bf16 v[200:203], v[24:27], v[232:235], v[200:203]
    ds_read_b64_tr_b16 v[168:169], v2 offset:4096
    v_mfma_f32_16x16x32_bf16 v[204:207], v[28:31], v[232:235], v[204:207]
    ds_read_b64_tr_b16 v[172:173], v3 offset:4096
    v_mfma_f32_16x16x32_bf16 v[208:211], v[128:131], v[232:235], v[208:211]
    ds_read_b64_tr_b16 v[176:177], v4 offset:4096
    v_mfma_f32_16x16x32_bf16 v[212:215], v[132:135], v[232:235], v[212:215]
    ds_read_b64_tr_b16 v[180:181], v5 offset:4096
    v_mfma_f32_16x16x32_bf16 v[216:219], v[136:139], v[232:235], v[216:219]
    ds_read_b64_tr_b16 v[184:185], v6 offset:4096
    v_mfma_f32_16x16x32_bf16 v[220:223], v[140:143], v[232:235], v[220:223]
    ds_read_b64_tr_b16 v[188:189], v7 offset:4096
    v_rcp_f32 v11, v244
    s_waitcnt vmcnt(2)
    s_cmp_eq_u32 s40, 3
    s_cbranch_scc1 L_qbw
    s_waitcnt vmcnt(0)
L_qbw:
    v_xor_b32 v237, 64, v171
    v_xor_b32 v238, 128, v171
    v_xor_b32 v239, 192, v171
    ds_read_b128 v[144:147], v171 offset:4096
    ds_read_b128 v[148:151], v237 offset:4096
    ds_read_b128 v[152:155], v238 offset:4096
    ds_read_b128 v[156:159], v239 offset:4096
    s_sub_u32 s47, s51, 32
    s_cmp_lt_u32 s47, 1968
    s_cbranch_scc1 L_fastB
    v_mul_f32 v192, v192, v11
    v_mul_f32 v193, v193, v11
    v_mul_f32 v194, v194, v11
    v_mul_f32 v195, v195, v11
    v_cvt_pk_bf16_f32 v192, v192, v193
    v_cvt_pk_bf16_f32 v193, v194, v195
    ds_write_b64 v8, v[192:193] offset:0
    v_mul_f32 v196, v196, v11
    v_mul_f32 v197, v197, v11
    v_mul_f32 v198, v198, v11
    v_mul_f32 v199, v199, v11
    v_cvt_pk_bf16_f32 v196, v196, v197
    v_cvt_pk_bf16_f32 v197, v198, v199
    ds_write_b64 v8, v[196:197] offset:32
    v_mul_f32 v200, v200, v11
    v_mul_f32 v201, v201, v11
    v_mul_f32 v202, v202, v11
    v_mul_f32 v203, v203, v11
    v_cvt_pk_bf16_f32 v200, v200, v201
    v_cvt_pk_bf16_f32 v201, v202, v203
    ds_write_b64 v8, v[200:201] offset:64
    v_mul_f32 v204, v204, v11
    v_mul_f32 v205, v205, v11
    v_mul_f32 v206, v206, v11
    v_mul_f32 v207, v207, v11
    v_cvt_pk_bf16_f32 v204, v204, v205
    v_cvt_pk_bf16_f32 v205, v206, v207
    ds_write_b64 v8, v[204:205] offset:96
    v_mul_f32 v208, v208, v11
    v_mul_f32 v209, v209, v11
    v_mul_f32 v210, v210, v11
    v_mul_f32 v211, v211, v11
    v_cvt_pk_bf16_f32 v208, v208, v209
    v_cvt_pk_bf16_f32 v209, v210, v211
    ds_write_b64 v8, v[208:209] offset:128
    v_mul_f32 v212, v212, v11
    v_mul_f32 v213, v213, v11
    v_mul_f32 v214, v214, v11
    v_mul_f32 v215, v215, v11
    v_cvt_pk_bf16_f32 v212, v212, v213
    v_cvt_pk_bf16_f32 v213, v214, v215
    ds_write_b64 v8, v[212:213] offset:160
    v_mul_f32 v216, v216, v11
    v_mul_f32 v217, v217, v11
    v_mul_f32 v218, v218, v11
    v_mul_f32 v219, v219, v11
    v_cvt_pk_bf16_f32 v216, v216, v217
    v_cvt_pk_bf16_f32 v217, v218, v219
    ds_write_b64 v8, v[216:217] offset:192
    v_mul_f32 v220, v220, v11
    v_mul_f32 v221, v221, v11
    v_mul_f32 v222, v222, v11
    v_mul_f32 v223, v223, v11
    v_cvt_pk_bf16_f32 v220, v220, v221
    v_cvt_pk_bf16_f32 v221, v222, v223
    ds_write_b64 v8, v[220:221] offset:224
    ds_read_b128 v[192:195], v9 offset:0
    ds_read_b128 v[196:199], v9 offset:1088
    ds_read_b128 v[200:203], v9 offset:2176
    ds_read_b128 v[204:207], v9 offset:3264
    s_waitcnt lgkmcnt(3)
    s_mov_b64 exec, s[56:57]
    buffer_store_dwordx4 v[192:195], v10, s[32:35], s3 offen offset:0 nt
    s_mov_b64 exec, -1
    s_waitcnt lgkmcnt(2)
    buffer_store_dwordx4 v[196:199], v10, s[32:35], s3 offen offset:1024 nt
    s_waitcnt lgkmcnt(1)
    buffer_store_dwordx4 v[200:203], v10, s[32:35], s3 offen offset:2048 nt
    s_waitcnt lgkmcnt(0)
    buffer_store_dwordx4 v[204:207], v10, s[32:35], s3 offen offset:3072 nt
    v_mfma_f32_16x16x32_bf16 v[224:227], v[80:83], v[144:147], 0
    v_mfma_f32_16x16x32_bf16 v[224:227], v[84:87], v[148:151], v[224:227]
    v_mfma_f32_16x16x32_bf16 v[224:227], v[88:91], v[152:155], v[224:227]
    v_mfma_f32_16x16x32_bf16 v[224:227], v[92:95], v[156:159], v[224:227]
    v_mfma_f32_16x16x32_bf16 v[228:231], v[96:99], v[144:147], v[252:255]
    v_mfma_f32_16x16x32_bf16 v[228:231], v[100:103], v[148:151], v[228:231]
    v_mfma_f32_16x16x32_bf16 v[228:231], v[104:107], v[152:155], v[228:231]
    v_mfma_f32_16x16x32_bf16 v[228:231], v[108:111], v[156:159], v[228:231]
    v_mfma_f32_16x16x32_bf16 v[232:235], v[48:51], v[144:147], 0
    v_mfma_f32_16x16x32_bf16 v[232:235], v[52:55], v[148:151], v[232:235]
    v_mfma_f32_16x16x32_bf16 v[232:235], v[56:59], v[152:155], v[232:235]
    v_mfma_f32_16x16x32_bf16 v[232:235], v[60:63], v[156:159], v[232:235]
    v_mfma_f32_16x16x32_bf16 v[236:239], v[64:67], v[144:147], 0
    v_mfma_f32_16x16x32_bf16 v[236:239], v[68:71], v[148:151], v[236:239]
    v_mfma_f32_16x16x32_bf16 v[236:239], v[72:75], v[152:155], v[236:239]
    v_mfma_f32_16x16x32_bf16 v[236:239], v[76:79], v[156:159], v[236:239]
    v_mfma_f32_16x16x32_bf16 v[240:243], v[32:35], v[144:147], v[248:251]
    v_mfma_f32_16x16x32_bf16 v[240:243], v[36:39], v[148:151], v[240:243]
    v_mfma_f32_16x16x32_bf16 v[240:243], v[40:43], v[152:155], v[240:243]
    v_mfma_f32_16x16x32_bf16 v[240:243], v[44:47], v[156:159], v[240:243]
    v_mfma_f32_16x16x32_bf16 v[244:247], v[112:115], v[144:147], 0
    v_mfma_f32_16x16x32_bf16 v[244:247], v[116:119], v[148:151], v[244:247]
    v_mfma_f32_16x16x32_bf16 v[244:247], v[120:123], v[152:155], v[244:247]
    v_mfma_f32_16x16x32_bf16 v[244:247], v[124:127], v[156:159], v[244:247]
    ds_read_b64_tr_b16 v[196:197], v0 offset:16384
    ds_read_b64_tr_b16 v[198:199], v0 offset:20480
    ds_read_b64_tr_b16 v[200:201], v1 offset:16384
    ds_read_b64_tr_b16 v[202:203], v1 offset:20480
    ds_read_b64_tr_b16 v[204:205], v2 offset:16384
    ds_read_b64_tr_b16 v[206:207], v2 offset:20480
    ds_read_b64_tr_b16 v[208:209], v3 offset:16384
    ds_read_b64_tr_b16 v[210:211], v3 offset:20480
    ds_read_b64_tr_b16 v[212:213], v4 offset:16384
    ds_read_b64_tr_b16 v[214:215], v4 offset:20480
    ds_read_b64_tr_b16 v[216:217], v5 offset:16384
    ds_read_b64_tr_b16 v[218:219], v5 offset:20480
    ds_read_b64_tr_b16 v[220:221], v6 offset:16384
    ds_read_b64_tr_b16 v[222:223], v6 offset:20480
    ds_read_b64_tr_b16 v[12:13], v7 offset:16384
    ds_read_b64_tr_b16 v[14:15], v7 offset:20480
    v_mbcnt_lo_u32_b32 v11, -1, 0
    v_mbcnt_hi_u32_b32 v11, -1, v11
    v_lshrrev_b32 v11, 4, v11
    s_sub_u32 s47, s51, 34
    s_movk_i32 s48, 2046
    v_lshl_add_u32 v11, v11, 2, s47
    v_mov_b32 v246, 0xff000000
    s_nop 3
    v_add_u32 v247, 64, v11
    v_cmp_gt_u32 vcc, s48, v247
    s_nop 1
    v_cndmask_b32 v224, v246, v224, vcc
    v_add_u32 v247, 65, v11
    v_cmp_gt_u32 vcc, s48, v247
    s_nop 1
    v_cndmask_b32 v225, v246, v225, vcc
    v_add_u32 v247, 66, v11
    v_cmp_gt_u32 vcc, s48, v247
    s_nop 1
    v_cndmask_b32 v226, v246, v226, vcc
    v_add_u32 v247, 67, v11
    v_cmp_gt_u32 vcc, s48, v247
    s_nop 1
    v_cndmask_b32 v227, v246, v227, vcc
    v_add_u32 v247, 80, v11
    v_cmp_gt_u32 vcc, s48, v247
    s_nop 1
    v_cndmask_b32 v228, v246, v228, vcc
    v_add_u32 v247, 81, v11
    v_cmp_gt_u32 vcc, s48, v247
    s_nop 1
    v_cndmask_b32 v229, v246, v229, vcc
    v_add_u32 v247, 82, v11
    v_cmp_gt_u32 vcc, s48, v247
    s_nop 1
    v_cndmask_b32 v230, v246, v230, vcc
    v_add_u32 v247, 83, v11
    v_cmp_gt_u32 vcc, s48, v247
    s_nop 1
    v_cndmask_b32 v231, v246, v231, vcc
    v_add_u32 v247, 32, v11
    v_cmp_gt_u32 vcc, s48, v247
    s_nop 1
    v_cndmask_b32 v232, v246, v232, vcc
    v_add_u32 v247, 33, v11
    v_cmp_gt_u32 vcc, s48, v247
    s_nop 1
    v_cndmask_b32 v233, v246, v233, vcc
    v_add_u32 v247, 34, v11
    v_cmp_gt_u32 vcc, s48, v247
    s_nop 1
    v_cndmask_b32 v234, v246, v234, vcc
    v_add_u32 v247, 35, v11
    v_cmp_gt_u32 vcc, s48, v247
    s_nop 1
    v_cndmask_b32 v235, v246, v235, vcc
    v_add_u32 v247, 48, v11
    v_cmp_gt_u32 vcc, s48, v247
    s_nop 1
    v_cndmask_b32 v236, v246, v236, vcc
    v_add_u32 v247, 49, v11
    v_cmp_gt_u32 vcc, s48, v247
    s_nop 1
    v_cndmask_b32 v237, v246, v237, vcc
    v_add_u32 v247, 50, v11
    v_cmp_gt_u32 vcc, s48, v247
    s_nop 1
    v_cndmask_b32 v238, v246, v238, vcc
    v_add_u32 v247, 51, v11
    v_cmp_gt_u32 vcc, s48, v247
    s_nop 1
    v_cndmask_b32 v239, v246, v239, vcc
    v_add_u32 v247, 16, v11
    v_cmp_gt_u32 vcc, s48, v247
    s_nop 1
    v_cndmask_b32 v240, v246, v240, vcc
    v_add_u32 v247, 17, v11
    v_cmp_gt_u32 vcc, s48, v247
    s_nop 1
    v_cndmask_b32 v241, v246, v241, vcc
    v_add_u32 v247, 18, v11
    v_cmp_gt_u32 vcc, s48, v247
    s_nop 1
    v_cndmask_b32 v242, v246, v242, vcc
    v_add_u32 v247, 19, v11
    v_cmp_gt_u32 vcc, s48, v247
    s_nop 1
    v_cndmask_b32 v243, v246, v243, vcc
    v_max3_f32 v246, v224, v225, v226
    v_max3_f32 v246, v246, v227, v228
    v_max3_f32 v246, v246, v229, v230
    v_max3_f32 v246, v246, v231, v232
    v_max3_f32 v246, v246, v233, v234
    v_max3_f32 v246, v246, v235, v236
    v_max3_f32 v246, v246, v237, v238
    v_max3_f32 v246, v246, v239, v240
    v_max3_f32 v246, v246, v241, v242
    v_max3_f32 v246, v246, v243, v244
    v_max_f32 v246, v246, v245
    s_branch L_joinB
L_fastB:
    v_mul_f32 v192, v192, v11
    v_mul_f32 v193, v193, v11
    v_mul_f32 v194, v194, v11
    v_mul_f32 v195, v195, v11
    v_cvt_pk_bf16_f32 v192, v192, v193
    v_cvt_pk_bf16_f32 v193, v194, v195
    ds_write_b64 v8, v[192:193] offset:0
    v_mul_f32 v196, v196, v11
    v_mul_f32 v197, v197, v11
    v_mul_f32 v198, v198, v11
    v_mul_f32 v199, v199, v11
    v_cvt_pk_bf16_f32 v196, v196, v197
    v_cvt_pk_bf16_f32 v197, v198, v199
    ds_write_b64 v8, v[196:197] offset:32
    s_waitcnt lgkmcnt(2)
    v_mfma_f32_16x16x32_bf16 v[224:227], v[80:83], v[144:147], 0
    v_mul_f32 v200, v200, v11
    v_mul_f32 v201, v201, v11
    v_mfma_f32_16x16x32_bf16 v[224:227], v[84:87], v[148:151], v[224:227]
    v_mul_f32 v202, v202, v11
    v_mul_f32 v203, v203, v11
    v_mfma_f32_16x16x32_bf16 v[224:227], v[88:91], v[152:155], v[224:227]
    v_cvt_pk_bf16_f32 v200, v200, v201
    v_cvt_pk_bf16_f32 v201, v202, v203
    v_mfma_f32_16x16x32_bf16 v[224:227], v[92:95], v[156:159], v[224:227]
    ds_write_b64 v8, v[200:201] offset:64
    v_mul_f32 v204, v204, v11
    v_mfma_f32_16x16x32_bf16 v[228:231], v[96:99], v[144:147], v[252:255]
    v_mul_f32 v205, v205, v11
    v_mul_f32 v206, v206, v11
    v_mfma_f32_16x16x32_bf16 v[228:231], v[100:103], v[148:151], v[228:231]
    v_mul_f32 v207, v207, v11
    v_cvt_pk_bf16_f32 v204, v204, v205
    v_mfma_f32_16x16x32_bf16 v[228:231], v[104:107], v[152:155], v[228:231]
    v_cvt_pk_bf16_f32 v205, v206, v207
    ds_write_b64 v8, v[204:205] offset:96
    v_mfma_f32_16x16x32_bf16 v[228:231], v[108:111], v[156:159], v[228:231]
    v_mul_f32 v208, v208, v11
    v_mul_f32 v209, v209, v11
    v_mfma_f32_16x16x32_bf16 v[232:235], v[48:51], v[144:147], 0
    v_mul_f32 v210, v210, v11
    v_mul_f32 v211, v211, v11
    v_mfma_f32_16x16x32_bf16 v[232:235], v[52:55], v[148:151], v[232:235]
    v_cvt_pk_bf16_f32 v208, v208, v209
    v_cvt_pk_bf16_f32 v209, v210, v211
    v_mfma_f32_16x16x32_bf16 v[232:235], v[56:59], v[152:155], v[232:235]
    ds_write_b64 v8, v[208:209] offset:128
    v_mul_f32 v212, v212, v11
    v_mfma_f32_16x16x32_bf16 v[232:235], v[60:63], v[156:159], v[232:235]
    v_mul_f32 v213, v213, v11
    v_mul_f32 v214, v214, v11
    v_mfma_f32_16x16x32_bf16 v[236:239], v[64:67], v[144:147], 0
    v_mul_f32 v215, v215, v11
    v_cvt_pk_bf16_f32 v212, v212, v213
    v_mfma_f32_16x16x32_bf16 v[236:239], v[68:71], v[148:151], v[236:239]
    v_cvt_pk_bf16_f32 v213, v214, v215
    ds_write_b64 v8, v[212:213] offset:160
    v_mfma_f32_16x16x32_bf16 v[236:239], v[72:75], v[152:155], v[236:239]
    v_mul_f32 v216, v216, v11
    v_mul_f32 v217, v217, v11
    v_mfma_f32_16x16x32_bf16 v[236:239], v[76:79], v[156:159], v[236:239]
    v_mul_f32 v218, v218, v11
    v_mul_f32 v219, v219, v11
    v_mfma_f32_16x16x32_bf16 v[240:243], v[32:35], v[144:147], v[248:251]
    v_cvt_pk_bf16_f32 v216, v216, v217
    v_cvt_pk_bf16_f32 v217, v218, v219
    v_mfma_f32_16x16x32_bf16 v[240:243], v[36:39], v[148:151], v[240:243]
    ds_write_b64 v8, v[216:217] offset:192
    v_mul_f32 v220, v220, v11
    v_mfma_f32_16x16x32_bf16 v[240:243], v[40:43], v[152:155], v[240:243]
    v_mul_f32 v221, v221, v11
    v_mul_f32 v222, v222, v11
    v_mfma_f32_16x16x32_bf16 v[240:243], v[44:47], v[156:159], v[240:243]
    v_mul_f32 v223, v223, v11
    v_cvt_pk_bf16_f32 v220, v220, v221
    v_mfma_f32_16x16x32_bf16 v[244:247], v[112:115], v[144:147], 0
    v_cvt_pk_bf16_f32 v221, v222, v223
    ds_write_b64 v8, v[220:221] offset:224
    v_mfma_f32_16x16x32_bf16 v[244:247], v[116:119], v[148:151], v[244:247]
    ds_read_b128 v[192:195], v9 offset:0
    ds_read_b128 v[196:199], v9 offset:1088
    v_mfma_f32_16x16x32_bf16 v[244:247], v[120:123], v[152:155], v[244:247]
    ds_read_b128 v[200:203], v9 offset:2176
    ds_read_b128 v[204:207], v9 offset:3264
    v_mfma_f32_16x16x32_bf16 v[244:247], v[124:127], v[156:159], v[244:247]
    v_max3_f32 v11, v224, v225, v226
    v_max3_f32 v11, v11, v227, v228
    v_max3_f32 v11, v11, v229, v230
    v_max3_f32 v11, v11, v231, v232
    v_max3_f32 v11, v11, v233, v234
    v_max3_f32 v11, v11, v235, v236
    v_max3_f32 v11, v11, v237, v238
    s_waitcnt lgkmcnt(3)
    s_mov_b64 exec, s[56:57]
    buffer_store_dwordx4 v[192:195], v10, s[32:35], s3 offen offset:0 nt
    s_mov_b64 exec, -1
    s_waitcnt lgkmcnt(2)
    buffer_store_dwordx4 v[196:199], v10, s[32:35], s3 offen offset:1024 nt
    s_waitcnt lgkmcnt(1)
    buffer_store_dwordx4 v[200:203], v10, s[32:35], s3 offen offset:2048 nt
    s_waitcnt lgkmcnt(0)
    buffer_store_dwordx4 v[204:207], v10, s[32:35], s3 offen offset:3072 nt
    ds_read_b64_tr_b16 v[196:197], v0 offset:16384
    ds_read_b64_tr_b16 v[198:199], v0 offset:20480
    ds_read_b64_tr_b16 v[200:201], v1 offset:16384
    ds_read_b64_tr_b16 v[202:203], v1 offset:20480
    ds_read_b64_tr_b16 v[204:205], v2 offset:16384
    ds_read_b64_tr_b16 v[206:207], v2 offset:20480
    ds_read_b64_tr_b16 v[208:209], v3 offset:16384
    ds_read_b64_tr_b16 v[210:211], v3 offset:20480
    ds_read_b64_tr_b16 v[212:213], v4 offset:16384
    ds_read_b64_tr_b16 v[214:215], v4 offset:20480
    ds_read_b64_tr_b16 v[216:217], v5 offset:16384
    ds_read_b64_tr_b16 v[218:219], v5 offset:20480
    ds_read_b64_tr_b16 v[220:221], v6 offset:16384
    ds_read_b64_tr_b16 v[222:223], v6 offset:20480
    ds_read_b64_tr_b16 v[12:13], v7 offset:16384
    ds_read_b64_tr_b16 v[14:15], v7 offset:20480
    v_max3_f32 v246, v11, v239, v240
    v_max3_f32 v246, v246, v241, v242
    v_max3_f32 v246, v246, v243, v244
    v_max_f32 v246, v246, v245
L_joinB:
    s_cmp_eq_u32 s58, 0
    s_cbranch_scc1 L_nohand
    v_mbcnt_lo_u32_b32 v112, -1, 0
    v_mbcnt_hi_u32_b32 v112, -1, v112
    v_lshlrev_b32 v112, 4, v112
    s_movk_i32 s47, 0
    buffer_load_dwordx4 v[48:51], v112, s[36:39], s47 offen sc0 sc1
    buffer_load_dwordx4 v[52:55], v112, s[36:39], s47 offen offset:1024 sc0 sc1
    s_movk_i32 s47, 2048
    buffer_load_dwordx4 v[56:59], v112, s[36:39], s47 offen sc0 sc1
    buffer_load_dwordx4 v[60:63], v112, s[36:39], s47 offen offset:1024 sc0 sc1
    s_movk_i32 s47, 4096
    buffer_load_dwordx4 v[64:67], v112, s[36:39], s47 offen sc0 sc1
    buffer_load_dwordx4 v[68:71], v112, s[36:39], s47 offen offset:1024 sc0 sc1
    s_movk_i32 s47, 6144
    buffer_load_dwordx4 v[72:75], v112, s[36:39], s47 offen sc0 sc1
    buffer_load_dwordx4 v[76:79], v112, s[36:39], s47 offen offset:1024 sc0 sc1
    s_movk_i32 s47, 8192
    buffer_load_dwordx4 v[80:83], v112, s[36:39], s47 offen sc0 sc1
    buffer_load_dwordx4 v[84:87], v112, s[36:39], s47 offen offset:1024 sc0 sc1
    s_movk_i32 s47, 10240
    buffer_load_dwordx4 v[88:91], v112, s[36:39], s47 offen sc0 sc1
    buffer_load_dwordx4 v[92:95], v112, s[36:39], s47 offen offset:1024 sc0 sc1
    s_movk_i32 s47, 12288
    buffer_load_dwordx4 v[96:99], v112, s[36:39], s47 offen sc0 sc1
    buffer_load_dwordx4 v[100:103], v112, s[36:39], s47 offen offset:1024 sc0 sc1
    s_movk_i32 s47, 14336
    buffer_load_dwordx4 v[104:107], v112, s[36:39], s47 offen sc0 sc1
    buffer_load_dwordx4 v[108:111], v112, s[36:39], s47 offen offset:1024 sc0 sc1
L_nohand:
    v_mov_b32 v247, v246
    s_nop 1
    v_permlane16_swap_b32 v246, v247
    v_max_f32 v246, v246, v247
    v_mov_b32 v247, v246
    s_nop 1
    v_permlane32_swap_b32 v246, v247
    v_max_f32 v246, v246, v247
    v_mul_f32 v246, s52, v246
    v_pk_fma_f32 v[224:225], v[224:225], s[52:53], v[246:247] op_sel_hi:[1,1,0] neg_lo:[0,0,1] neg_hi:[0,0,1]
    v_pk_fma_f32 v[226:227], v[226:227], s[52:53], v[246:247] op_sel_hi:[1,1,0] neg_lo:[0,0,1] neg_hi:[0,0,1]
    v_pk_fma_f32 v[228:229], v[228:229], s[52:53], v[246:247] op_sel_hi:[1,1,0] neg_lo:[0,0,1] neg_hi:[0,0,1]
    v_pk_fma_f32 v[230:231], v[230:231], s[52:53], v[246:247] op_sel_hi:[1,1,0] neg_lo:[0,0,1] neg_hi:[0,0,1]
    v_exp_f32 v224, v224
    v_exp_f32 v225, v225
    v_exp_f32 v226, v226
    v_exp_f32 v227, v227
    v_exp_f32 v228, v228
    v_exp_f32 v229, v229
    v_exp_f32 v230, v230
    v_exp_f32 v231, v231
    v_pk_fma_f32 v[240:241], v[240:241], s[52:53], v[246:247] op_sel_hi:[1,1,0] neg_lo:[0,0,1] neg_hi:[0,0,1]
    v_cvt_pk_bf16_f32 v224, v224, v225
    v_cvt_pk_bf16_f32 v225, v226, v227
    v_cvt_pk_bf16_f32 v226, v228, v229
    v_cvt_pk_bf16_f32 v227, v230, v231
    v_pk_fma_f32 v[242:243], v[242:243], s[52:53], v[246:247] op_sel_hi:[1,1,0] neg_lo:[0,0,1] neg_hi:[0,0,1]
    s_waitcnt lgkmcnt(0)
    v_mfma_f32_16x16x32_bf16 v[192:195], v[196:199], v[224:227], 0
    v_pk_fma_f32 v[244:245], v[244:245], s[52:53], v[246:247] op_sel_hi:[1,1,0] neg_lo:[0,0,1] neg_hi:[0,0,1]
    v_exp_f32 v240, v240
    v_mfma_f32_16x16x32_bf16 v[196:199], v[200:203], v[224:227], 0
    v_exp_f32 v241, v241
    v_exp_f32 v242, v242
    v_mfma_f32_16x16x32_bf16 v[200:203], v[204:207], v[224:227], 0
    v_exp_f32 v243, v243
    v_exp_f32 v244, v244
    v_mfma_f32_16x16x32_bf16 v[204:207], v[208:211], v[224:227], 0
    v_exp_f32 v245, v245
    v_mov_b32 v228, 0x3f803f80
    v_mfma_f32_16x16x32_bf16 v[208:211], v[212:215], v[224:227], 0
    v_mov_b32 v229, 0x3f803f80
    v_mov_b32 v230, 0x3f803f80
    v_mfma_f32_16x16x32_bf16 v[212:215], v[216:219], v[224:227], 0
    v_mov_b32 v231, 0x3f803f80
    v_cvt_pk_bf16_f32 v240, v240, v241
    v_mfma_f32_16x16x32_bf16 v[216:219], v[220:223], v[224:227], 0
    v_cvt_pk_bf16_f32 v241, v242, v243
    v_cvt_pk_bf16_f32 v242, v244, v245
    v_mfma_f32_16x16x32_bf16 v[220:223], v[12:15], v[224:227], 0
    v_mov_b32 v243, 0
    v_cndmask_b32 v242, 0, v242, s[54:55]
    v_pk_fma_f32 v[232:233], v[232:233], s[52:53], v[246:247] op_sel_hi:[1,1,0] neg_lo:[0,0,1] neg_hi:[0,0,1]
    v_pk_fma_f32 v[234:235], v[234:235], s[52:53], v[246:247] op_sel_hi:[1,1,0] neg_lo:[0,0,1] neg_hi:[0,0,1]
    v_mfma_f32_16x16x32_bf16 v[192:195], v[160:163], v[240:243], v[192:195]
    v_pk_fma_f32 v[236:237], v[236:237], s[52:53], v[246:247] op_sel_hi:[1,1,0] neg_lo:[0,0,1] neg_hi:[0,0,1]
    v_pk_fma_f32 v[238:239], v[238:239], s[52:53], v[246:247] op_sel_hi:[1,1,0] neg_lo:[0,0,1] neg_hi:[0,0,1]
    v_mfma_f32_16x16x32_bf16 v[196:199], v[164:167], v[240:243], v[196:199]
    v_exp_f32 v232, v232
    v_exp_f32 v233, v233
    v_mfma_f32_16x16x32_bf16 v[200:203], v[168:171], v[240:243], v[200:203]
    v_exp_f32 v234, v234
    v_exp_f32 v235, v235
    v_mfma_f32_16x16x32_bf16 v[204:207], v[172:175], v[240:243], v[204:207]
    v_exp_f32 v236, v236
    v_exp_f32 v237, v237
    v_mfma_f32_16x16x32_bf16 v[208:211], v[176:179], v[240:243], v[208:211]
    v_exp_f32 v238, v238
    v_exp_f32 v239, v239
    v_mfma_f32_16x16x32_bf16 v[212:215], v[180:183], v[240:243], v[212:215]
    v_mov_b32 v11, 0
    v_cvt_pk_bf16_f32 v232, v232, v233
    v_mfma_f32_16x16x32_bf16 v[216:219], v[184:187], v[240:243], v[216:219]
    v_cvt_pk_bf16_f32 v233, v234, v235
    v_cvt_pk_bf16_f32 v234, v236, v237
    v_mfma_f32_16x16x32_bf16 v[220:223], v[188:191], v[240:243], v[220:223]
    v_cvt_pk_bf16_f32 v235, v238, v239
    v_mfma_f32_16x16x32_bf16 v[244:247], v[228:231], v[224:227], 0
    v_mfma_f32_16x16x32_bf16 v[244:247], v[228:231], v[240:243], v[244:247]
    v_mfma_f32_16x16x32_bf16 v[244:247], v[228:231], v[232:235], v[244:247]
    v_mfma_f32_16x16x32_bf16 v[192:195], v[16:19], v[232:235], v[192:195]
    v_mfma_f32_16x16x32_bf16 v[196:199], v[20:23], v[232:235], v[196:199]
    v_mfma_f32_16x16x32_bf16 v[200:203], v[24:27], v[232:235], v[200:203]
    v_mfma_f32_16x16x32_bf16 v[204:207], v[28:31], v[232:235], v[204:207]
    v_mfma_f32_16x16x32_bf16 v[208:211], v[128:131], v[232:235], v[208:211]
    v_mfma_f32_16x16x32_bf16 v[212:215], v[132:135], v[232:235], v[212:215]
    v_mfma_f32_16x16x32_bf16 v[216:219], v[136:139], v[232:235], v[216:219]
    v_mfma_f32_16x16x32_bf16 v[220:223], v[140:143], v[232:235], v[220:223]
    v_rcp_f32 v11, v244
    s_nop 0
    v_mul_f32 v192, v192, v11
    v_mul_f32 v193, v193, v11
    v_mul_f32 v194, v194, v11
    v_mul_f32 v195, v195, v11
    v_cvt_pk_bf16_f32 v192, v192, v193
    v_cvt_pk_bf16_f32 v193, v194, v195
    ds_write_b64 v8, v[192:193] offset:0
    v_mul_f32 v196, v196, v11
    v_mul_f32 v197, v197, v11
    v_mul_f32 v198, v198, v11
    v_mul_f32 v199, v199, v11
    v_cvt_pk_bf16_f32 v196, v196, v197
    v_cvt_pk_bf16_f32 v197, v198, v199
    ds_write_b64 v8, v[196:197] offset:32
    v_mul_f32 v200, v200, v11
    v_mul_f32 v201, v201, v11
    v_mul_f32 v202, v202, v11
    v_mul_f32 v203, v203, v11
    v_cvt_pk_bf16_f32 v200, v200, v201
    v_cvt_pk_bf16_f32 v201, v202, v203
    ds_write_b64 v8, v[200:201] offset:64
    v_mul_f32 v204, v204, v11
    v_mul_f32 v205, v205, v11
    v_mul_f32 v206, v206, v11
    v_mul_f32 v207, v207, v11
    v_cvt_pk_bf16_f32 v204, v204, v205
    v_cvt_pk_bf16_f32 v205, v206, v207
    ds_write_b64 v8, v[204:205] offset:96
    v_mul_f32 v208, v208, v11
    v_mul_f32 v209, v209, v11
    v_mul_f32 v210, v210, v11
    v_mul_f32 v211, v211, v11
    v_cvt_pk_bf16_f32 v208, v208, v209
    v_cvt_pk_bf16_f32 v209, v210, v211
    ds_write_b64 v8, v[208:209] offset:128
    v_mul_f32 v212, v212, v11
    v_mul_f32 v213, v213, v11
    v_mul_f32 v214, v214, v11
    v_mul_f32 v215, v215, v11
    v_cvt_pk_bf16_f32 v212, v212, v213
    v_cvt_pk_bf16_f32 v213, v214, v215
    ds_write_b64 v8, v[212:213] offset:160
    v_mul_f32 v216, v216, v11
    v_mul_f32 v217, v217, v11
    v_mul_f32 v218, v218, v11
    v_mul_f32 v219, v219, v11
    v_cvt_pk_bf16_f32 v216, v216, v217
    v_cvt_pk_bf16_f32 v217, v218, v219
    ds_write_b64 v8, v[216:217] offset:192
    v_mul_f32 v220, v220, v11
    v_mul_f32 v221, v221, v11
    v_mul_f32 v222, v222, v11
    v_mul_f32 v223, v223, v11
    v_cvt_pk_bf16_f32 v220, v220, v221
    v_cvt_pk_bf16_f32 v221, v222, v223
    ds_write_b64 v8, v[220:221] offset:224
    ds_read_b128 v[192:195], v9 offset:0
    ds_read_b128 v[196:199], v9 offset:1088
    ds_read_b128 v[200:203], v9 offset:2176
    ds_read_b128 v[204:207], v9 offset:3264
    s_waitcnt lgkmcnt(3)
    buffer_store_dwordx4 v[192:195], v10, s[32:35], s41 offen offset:0 nt
    s_waitcnt lgkmcnt(2)
    buffer_store_dwordx4 v[196:199], v10, s[32:35], s41 offen offset:1024 nt
    s_waitcnt lgkmcnt(1)
    buffer_store_dwordx4 v[200:203], v10, s[32:35], s41 offen offset:2048 nt
    s_waitcnt lgkmcnt(0)
    buffer_store_dwordx4 v[204:207], v10, s[32:35], s41 offen offset:3072 nt
    s_cmp_eq_u32 s58, 0
    s_cbranch_scc1 L_fin
    s_waitcnt vmcnt(4)
    s_mov_b32 s59, 0
    s_mov_b32 s49, 0
L_chk:
    s_mov_b32 s50, s49
    v_cmp_eq_u32 vcc, s63, v51
    v_cmp_eq_u32 s[60:61], s63, v55
    s_nop 0
    s_and_b64 vcc, vcc, s[60:61]
    s_cmp_eq_u64 vcc, exec
    s_cselect_b32 s47, 1, 0
    s_or_b32 s50, s50, s47
    v_cmp_eq_u32 vcc, s63, v59
    v_cmp_eq_u32 s[60:61], s63, v63
    s_nop 0
    s_and_b64 vcc, vcc, s[60:61]
    s_cmp_eq_u64 vcc, exec
    s_cselect_b32 s47, 2, 0
    s_or_b32 s50, s50, s47
    v_cmp_eq_u32 vcc, s63, v67
    v_cmp_eq_u32 s[60:61], s63, v71
    s_nop 0
    s_and_b64 vcc, vcc, s[60:61]
    s_cmp_eq_u64 vcc, exec
    s_cselect_b32 s47, 4, 0
    s_or_b32 s50, s50, s47
    v_cmp_eq_u32 vcc, s63, v75
    v_cmp_eq_u32 s[60:61], s63, v79
    s_nop 0
    s_and_b64 vcc, vcc, s[60:61]
    s_cmp_eq_u64 vcc, exec
    s_cselect_b32 s47, 8, 0
    s_or_b32 s50, s50, s47
    v_cmp_eq_u32 vcc, s63, v83
    v_cmp_eq_u32 s[60:61], s63, v87
    s_nop 0
    s_and_b64 vcc, vcc, s[60:61]
    s_cmp_eq_u64 vcc, exec
    s_cselect_b32 s47, 16, 0
    s_or_b32 s50, s50, s47
    v_cmp_eq_u32 vcc, s63, v91
    v_cmp_eq_u32 s[60:61], s63, v95
    s_nop 0
    s_and_b64 vcc, vcc, s[60:61]
    s_cmp_eq_u64 vcc, exec
    s_cselect_b32 s47, 32, 0
    s_or_b32 s50, s50, s47
    v_cmp_eq_u32 vcc, s63, v99
    v_cmp_eq_u32 s[60:61], s63, v103
    s_nop 0
    s_and_b64 vcc, vcc, s[60:61]
    s_cmp_eq_u64 vcc, exec
    s_cselect_b32 s47, 64, 0
    s_or_b32 s50, s50, s47
    v_cmp_eq_u32 vcc, s63, v107
    v_cmp_eq_u32 s[60:61], s63, v111
    s_nop 0
    s_and_b64 vcc, vcc, s[60:61]
    s_cmp_eq_u64 vcc, exec
    s_cselect_b32 s47, 128, 0
    s_or_b32 s50, s50, s47
    s_add_u32 s59, s59, 1
    s_cmp_eq_u32 s50, 0xff
    s_cbranch_scc1 L_ready
    s_cmp_ge_u32 s59, 0x40000
    s_cbranch_scc1 L_ready
    s_lshl_b32 s47, s43, 3
    v_mov_b32 v113, s47
    global_load_dword v114, v113, s[16:17] offset:4 sc0 sc1
    s_waitcnt vmcnt(0)
    v_readfirstlane_b32 s49, v114
    v_mbcnt_lo_u32_b32 v112, -1, 0
    v_mbcnt_hi_u32_b32 v112, -1, v112
    v_lshlrev_b32 v112, 4, v112
    s_movk_i32 s47, 0
    buffer_load_dwordx4 v[48:51], v112, s[36:39], s47 offen sc0 sc1
    buffer_load_dwordx4 v[52:55], v112, s[36:39], s47 offen offset:1024 sc0 sc1
    s_movk_i32 s47, 2048
    buffer_load_dwordx4 v[56:59], v112, s[36:39], s47 offen sc0 sc1
    buffer_load_dwordx4 v[60:63], v112, s[36:39], s47 offen offset:1024 sc0 sc1
    s_movk_i32 s47, 4096
    buffer_load_dwordx4 v[64:67], v112, s[36:39], s47 offen sc0 sc1
    buffer_load_dwordx4 v[68:71], v112, s[36:39], s47 offen offset:1024 sc0 sc1
    s_movk_i32 s47, 6144
    buffer_load_dwordx4 v[72:75], v112, s[36:39], s47 offen sc0 sc1
    buffer_load_dwordx4 v[76:79], v112, s[36:39], s47 offen offset:1024 sc0 sc1
    s_movk_i32 s47, 8192
    buffer_load_dwordx4 v[80:83], v112, s[36:39], s47 offen sc0 sc1
    buffer_load_dwordx4 v[84:87], v112, s[36:39], s47 offen offset:1024 sc0 sc1
    s_movk_i32 s47, 10240
    buffer_load_dwordx4 v[88:91], v112, s[36:39], s47 offen sc0 sc1
    buffer_load_dwordx4 v[92:95], v112, s[36:39], s47 offen offset:1024 sc0 sc1
    s_movk_i32 s47, 12288
    buffer_load_dwordx4 v[96:99], v112, s[36:39], s47 offen sc0 sc1
    buffer_load_dwordx4 v[100:103], v112, s[36:39], s47 offen offset:1024 sc0 sc1
    s_movk_i32 s47, 14336
    buffer_load_dwordx4 v[104:107], v112, s[36:39], s47 offen sc0 sc1
    buffer_load_dwordx4 v[108:111], v112, s[36:39], s47 offen offset:1024 sc0 sc1
    s_waitcnt vmcnt(0)
    s_branch L_chk
L_ready:
    v_max3_f32 v12, v53, v61, v69
    v_max3_f32 v12, v12, v77, v85
    v_max3_f32 v12, v12, v93, v101
    v_max_f32 v12, v12, v109
    v_sub_f32 v53, v53, v12
    v_sub_f32 v61, v61, v12
    v_sub_f32 v69, v69, v12
    v_sub_f32 v77, v77, v12
    v_sub_f32 v85, v85, v12
    v_sub_f32 v93, v93, v12
    v_sub_f32 v101, v101, v12
    v_sub_f32 v109, v109, v12
    v_exp_f32 v53, v53
    v_exp_f32 v61, v61
    v_exp_f32 v69, v69
    v_exp_f32 v77, v77
    v_exp_f32 v85, v85
    v_exp_f32 v93, v93
    v_exp_f32 v101, v101
    v_exp_f32 v109, v109
    s_nop 0
    v_mul_f32 v48, v48, v53
    v_mul_f32 v49, v49, v53
    v_mul_f32 v50, v50, v53
    v_mul_f32 v52, v52, v53
    v_mul_f32 v54, v54, v53
    v_fmac_f32 v48, v56, v61
    v_fmac_f32 v49, v57, v61
    v_fmac_f32 v50, v58, v61
    v_fmac_f32 v52, v60, v61
    v_fmac_f32 v54, v62, v61
    v_fmac_f32 v48, v64, v69
    v_fmac_f32 v49, v65, v69
    v_fmac_f32 v50, v66, v69
    v_fmac_f32 v52, v68, v69
    v_fmac_f32 v54, v70, v69
    v_fmac_f32 v48, v72, v77
    v_fmac_f32 v49, v73, v77
    v_fmac_f32 v50, v74, v77
    v_fmac_f32 v52, v76, v77
    v_fmac_f32 v54, v78, v77
    v_fmac_f32 v48, v80, v85
    v_fmac_f32 v49, v81, v85
    v_fmac_f32 v50, v82, v85
    v_fmac_f32 v52, v84, v85
    v_fmac_f32 v54, v86, v85
    v_fmac_f32 v48, v88, v93
    v_fmac_f32 v49, v89, v93
    v_fmac_f32 v50, v90, v93
    v_fmac_f32 v52, v92, v93
    v_fmac_f32 v54, v94, v93
    v_fmac_f32 v48, v96, v101
    v_fmac_f32 v49, v97, v101
    v_fmac_f32 v50, v98, v101
    v_fmac_f32 v52, v100, v101
    v_fmac_f32 v54, v102, v101
    v_fmac_f32 v48, v104, v109
    v_fmac_f32 v49, v105, v109
    v_fmac_f32 v50, v106, v109
    v_fmac_f32 v52, v108, v109
    v_fmac_f32 v54, v110, v109
    v_rcp_f32 v12, v54
    v_lshrrev_b32 v112, 1, v112
    v_mul_f32 v48, v48, v12
    v_mul_f32 v49, v49, v12
    v_mul_f32 v50, v50, v12
    v_mul_f32 v52, v52, v12
    v_cvt_pk_bf16_f32 v14, v48, v49
    v_cvt_pk_bf16_f32 v15, v50, v52
    buffer_store_dwordx2 v[14:15], v112, s[32:35], 0 offen nt
L_fin:
L_end:
    s_endpgm
.fill (L_base + 12352 - .) / 4, 4, 0xbf810000
.section .rodata,"a"
.p2align 6
.amdhsa_kernel standalone__global_local_windowed_global_tokens__prompt_kernel
  .amdhsa_next_free_vgpr 256
  .amdhsa_next_free_sgpr 64
  .amdhsa_accum_offset 256
  .amdhsa_group_segment_fixed_size 0
  .amdhsa_kernarg_size 64
  .amdhsa_user_sgpr_count 2
  .amdhsa_user_sgpr_kernarg_segment_ptr 1
  .amdhsa_system_sgpr_workgroup_id_x 1
.end_amdhsa_kernel
```
